```python
import torch

def _softmax(x, axis=-1):
    return torch.softmax(x, dim=axis)
def _gelu(x):
    return torch.nn.functional.gelu(x, approximate="tanh")
def _silu(x):
    return torch.nn.functional.silu(x)
def _sigmoid(x):
    return torch.sigmoid(x)
def _layernorm(x, axis=-1, eps=1e-5):
    m = x.mean(dim=axis, keepdim=True)
    v = x.var(dim=axis, keepdim=True, unbiased=False)
    return (x - m) / torch.sqrt(v + eps)
def _scatter_add(tgt, idx, src, axis=0):
    return tgt.clone().index_add_(axis, idx, src)
def _segment_sum(src, seg, n):
    out = torch.zeros((n,) + src.shape[1:], dtype=src.dtype)
    return out.index_add_(0, seg, src)
def _pad(x, pw):
    flat = tuple(v for pair in reversed(pw) for v in pair)
    return torch.nn.functional.pad(x, flat)

kernel_name = 'standalone__edge_featured_mpnn_mpnn__graph'

def setup_inputs():

    _w = (lambda a: (lambda t: t.to(torch.bfloat16) if t.is_floating_point() else t)(torch.as_tensor(a)))
    N, deg, D, De = 25000, 16, 128, max(0, 1)
    E = N * deg
    H = 2 * D
    return {
        "x": _w((lambda *s: torch.randn(*s, dtype=torch.bfloat16) * 0.05)(N, D)),
        "e_attr": _w((lambda *s: torch.randn(*s, dtype=torch.bfloat16) * 1.6)(E, De)),
        "src": _w((lambda lo, hi, *s: torch.randint(lo, hi, s))(0, N, E).to(torch.int64)),
        "dst": _w((lambda lo, hi, *s: torch.randint(lo, hi, s))(0, N, E).to(torch.int64)),
        "w1": _w((lambda *s: torch.randn(*s, dtype=torch.bfloat16) * 1.6)(2 * D + De, H) * (1.0 / (2 * D + De) ** 0.5)),
        "b1": _w((lambda *s: torch.randn(*s, dtype=torch.bfloat16) * 1.6)(H) * 0.01),
        "w2": _w((lambda *s: torch.randn(*s, dtype=torch.bfloat16) * 0.05)(H, D) * (1.0 / H ** 0.5)),
        "b2": _w((lambda *s: torch.randn(*s, dtype=torch.bfloat16) * 0.05)(D) * 0.01),
    }

def reference(x, e_attr, src, dst, w1, b1, w2, b2):
    N, D = x.shape
    h_src = x[src]
    h_dst = x[dst]
    m_in = torch.concatenate([h_src, h_dst, e_attr], axis=-1)
    h = _silu(m_in @ w1 + b1)
    msg = h @ w2 + b2
    return _segment_sum(msg, dst, N)
```

```asm
; @launch grid=(256,1,1) block=(1024,1,1) lds=163840
.amdgcn_target "amdgcn-amd-amdhsa--gfx950"
.text
.globl standalone__edge_featured_mpnn_mpnn__graph_kernel
.p2align 12
.type standalone__edge_featured_mpnn_mpnn__graph_kernel,@function
standalone__edge_featured_mpnn_mpnn__graph_kernel:
    s_cmp_ge_u32 s2, 256
    s_cbranch_scc1 L_end
    s_load_dwordx16 s[4:19], s[0:1], 0
    s_load_dwordx2 s[20:21], s[0:1], 64
    s_load_dwordx2 s[24:25], s[0:1], 80
    s_load_dwordx2 s[0:1], s[0:1], 72
    v_lshrrev_b32 v1, 6, v0
    v_and_b32 v0, 63, v0
    v_readfirstlane_b32 s3, v1
    v_mov_b32 v42, 0
    v_mov_b32 v41, 0
    s_cmp_lg_u32 s3, 15
    s_cbranch_scc1 L_noinit
    v_mov_b64 v[16:17], 0
    v_mov_b64 v[18:19], 0
    s_mov_b32 s56, 131328
    v_lshl_add_u32 v2, v0, 4, s56
    v_lshlrev_b32 v23, 2, v0
    v_sub_u32 v20, 127, v0
    v_sub_u32 v21, 63, v0
    ds_write_b128 v2, v[16:19]
    ds_write_b32 v23, v16
    ds_write2st64_b32 v23, v20, v21 offset0:1 offset1:2
L_noinit:
    s_mov_b32 s26, 0xffff0000
    s_mov_b32 s54, 0
    s_mov_b32 s55, 0
    s_mov_b32 s48, s2
    s_and_b32 s53, s2, 7
    s_lshl_b32 s53, s53, 5
    s_lshr_b32 s27, s2, 3
    s_or_b32 s53, s53, s27
    s_mul_i32 s51, s53, 6400845
    s_add_u32 s51, s51, 65535
    s_add_u32 s52, s51, 6400845
    s_lshr_b32 s51, s51, 16
    s_lshr_b32 s52, s52, 16
    s_min_u32 s52, s52, 25000
    s_mov_b32 s49, s51
    s_mov_b32 s50, s52
    s_sub_u32 s52, s52, s51
    s_sub_u32 s62, s3, 8
    s_mov_b32 s31, 0x00020000
    s_mov_b32 s35, 0x00020000
    s_mov_b32 s38, 800000
    s_mov_b32 s39, 0x00020000
    s_mov_b32 s46, 0x10000000
    s_mov_b32 s70, 249561088
    s_mov_b32 s47, 0x00020000
    s_cmp_lt_u32 s3, 8
    s_cbranch_scc1 L_Gfirst
    s_lshl_b32 s56, s62, 6
    v_add_u32 v1, s56, v0
    s_mul_i32 s57, s2, 1564
    v_lshl_add_u32 v2, v1, 2, s57
    v_lshlrev_b32 v3, 2, v2
    v_lshlrev_b32 v4, 1, v2
    s_mov_b32 s30, 1600000
    s_mov_b32 s34, 1600000
    s_cmp_eq_u32 s3, 15
    s_cbranch_scc1 L_W15
    s_waitcnt lgkmcnt(0)
    s_mov_b32 s28, s10
    s_mov_b32 s29, s11
    s_mov_b32 s32, s8
    s_mov_b32 s33, s9
    s_mov_b32 s36, s6
    s_mov_b32 s37, s7
    buffer_load_dwordx4 v[44:47], v3, s[28:31], 0 offen nt
    buffer_load_dwordx4 v[48:51], v3, s[32:35], 0 offen nt
    buffer_load_dwordx2 v[52:53], v4, s[36:39], 0 offen nt
    s_barrier
    s_branch L_Lcont
L_W15:
    v_lshrrev_b32 v52, 3, v0
    v_lshlrev_b32 v52, 13, v52
    v_and_b32 v23, 7, v0
    v_lshl_add_u32 v52, v23, 7, v52
    v_lshlrev_b32 v23, 2, v0
    s_and_b32 s23, s2, 7
    s_lshl_b32 s23, s23, 10
    s_add_u32 s23, s23, 266862592
    s_lshr_b32 s56, s2, 3
    s_lshl_b32 s56, s56, 11
    v_lshl_add_u32 v28, v0, 7, s56
    v_add_u32 v29, 0x10000, v28
    v_lshrrev_b32 v32, 3, v0
    v_lshlrev_b32 v32, 6, v32
    v_and_b32 v33, 1, v0
    v_lshl_add_u32 v32, v33, 5, v32
    v_bfe_u32 v33, v0, 1, 2
    v_lshl_add_u32 v32, v33, 3, v32
    v_add_u32 v33, 0x20000, v32
    v_lshrrev_b32 v34, 1, v28
    v_and_b32 v34, 0xffffff80, v34
    s_getpc_b64 s[56:57]
L_pc:
    s_mov_b32 s58, L_last-L_pc
    s_waitcnt lgkmcnt(0)
    s_mov_b32 s44, s24
    s_mov_b32 s45, s25
    s_mov_b64 exec, 0xffff
    buffer_load_dword v53, v52, s[44:47], s23 offen sc1
    global_load_dword v55, v42, s[0:1] sc1
    v_cmp_gt_u32 vcc, s58, v34
    s_and_b64 exec, exec, vcc
    s_cbranch_execz L_nocpf
    global_load_dword v35, v34, s[56:57]
L_nocpf:
    s_mov_b64 exec, 0xffff
    global_load_dword v30, v28, s[12:13]
    global_load_dword v30, v29, s[12:13]
    global_load_dword v31, v28, s[16:17]
    s_mov_b64 exec, -1
    global_load_dwordx2 v[36:37], v33, s[12:13]
    global_load_dwordx2 v[38:39], v32, s[14:15]
    s_barrier
    s_mov_b64 exec, 0
    s_branch L_stub1
    s_branch L_W15cont
L_Gfirst:
    v_lshrrev_b32 v7, 4, v0
    v_and_b32 v6, 15, v0
    v_xor_b32 v6, v6, v7
    s_and_b32 s61, s3, 3
    s_lshl_b32 s61, s61, 2
    v_xor_b32 v6, s61, v6
    v_lshlrev_b32 v6, 4, v6
    v_lshl_add_u32 v6, v7, 8, v6
    s_lshl_b32 s61, s3, 10
    s_add_u32 s64, s61, 133376
    s_lshl_b32 s65, s49, 8
    s_add_u32 s65, s65, s61
    v_lshrrev_b32 v5, 2, v0
    v_lshlrev_b32 v5, 9, v5
    v_lshrrev_b32 v8, 5, v0
    v_lshlrev_b32 v8, 1, v8
    v_and_b32 v3, 3, v0
    v_xor_b32 v8, v8, v3
    v_lshl_add_u32 v5, v8, 4, v5
    s_lshl_b32 s56, s3, 6
    v_add_u32 v1, s56, v5
    s_mul_i32 s59, s3, 14336
    s_add_u32 s59, s59, 4096
    s_mov_b32 s30, 131584
    s_mov_b32 s34, 6400000
    s_waitcnt lgkmcnt(0)
    s_mov_b32 s28, s12
    s_mov_b32 s29, s13
    s_mov_b32 s32, s4
    s_mov_b32 s33, s5
    s_barrier
    s_mov_b32 m0, s64
    s_nop 0
    buffer_load_dwordx4 v6, s[32:35], s65 offen nt lds
    s_add_u32 m0, m0, 8192
    s_add_u32 s65, s65, 8192
    buffer_load_dwordx4 v6, s[32:35], s65 offen nt lds
    s_add_u32 m0, m0, 8192
    s_add_u32 s65, s65, 8192
    buffer_load_dwordx4 v6, s[32:35], s65 offen nt lds
    s_add_u32 m0, m0, 8192
    s_add_u32 s65, s65, 8192
    s_cmp_lg_u32 s3, 0
    s_cbranch_scc1 L_Gw
    buffer_load_dwordx4 v6, s[32:35], s65 offen nt lds
L_Gw:
    s_add_u32 m0, s59, 0
    s_mov_b32 s56, 0
    buffer_load_dwordx4 v1, s[28:31], s56 offen lds
    s_add_u32 m0, m0, 1024
    s_add_u32 s56, s56, 8192
    buffer_load_dwordx4 v1, s[28:31], s56 offen lds
    s_add_u32 m0, m0, 1024
    s_add_u32 s56, s56, 8192
    buffer_load_dwordx4 v1, s[28:31], s56 offen lds
    s_add_u32 m0, m0, 1024
    s_add_u32 s56, s56, 8192
    buffer_load_dwordx4 v1, s[28:31], s56 offen lds
    s_add_u32 m0, m0, 1024
    s_add_u32 s56, s56, 8192
    buffer_load_dwordx4 v1, s[28:31], s56 offen lds
    s_add_u32 m0, m0, 1024
    s_add_u32 s56, s56, 8192
    buffer_load_dwordx4 v1, s[28:31], s56 offen lds
    s_add_u32 m0, m0, 1024
    s_add_u32 s56, s56, 8192
    buffer_load_dwordx4 v1, s[28:31], s56 offen lds
    s_add_u32 m0, m0, 1024
    s_add_u32 s56, s56, 8192
    buffer_load_dwordx4 v1, s[28:31], s56 offen lds
    s_branch L_Gcont
L_Lcont:
    s_mov_b64 exec, -1
    s_setprio 2
    s_mov_b32 s23, 0
    s_mov_b32 s44, s24
    s_mov_b32 s45, s25
    s_mov_b32 s36, s6
    s_mov_b32 s37, s7
    s_mov_b32 s40, s24
    s_and_b32 s41, s25, 0xffff
    s_or_b32 s41, s41, 0x00100000
    s_mov_b32 s42, 64
    s_mov_b32 s43, 0x00800000
    s_lshl_b32 s99, s2, 10
    s_add_u32 s99, s99, 266600448
    v_lshlrev_b32 v14, 4, v0
    v_lshrrev_b32 v27, 1, v0
    s_lshl_b32 s56, s62, 5
    v_add_u32 v27, s56, v27
    v_lshlrev_b32 v25, 10, v27
    s_lshl_b32 s98, s53, 2
    s_add_u32 s98, s98, 266600448
    v_cmp_gt_u32 vcc, 391, v1
    v_mov_b32 v3, 400000
    v_cmp_gt_u32 s[96:97], v3, v2
    s_and_b64 s[96:97], s[96:97], vcc
    v_mov_b32 v10, 1
    s_movk_i32 s56, 2684
    s_mov_b32 s57, 131328
    s_movk_i32 s58, 24999
    v_lshl_add_u32 v11, v0, 4, s57
    s_waitcnt vmcnt(2)
    s_mov_b64 exec, s[96:97]
    v_min_u32 v44, s58, v44
    v_mul_u32_u24 v54, s56, v44
    v_lshrrev_b32 v54, 18, v54
    v_lshl_add_u32 v54, v54, 2, s57
    ds_add_rtn_u32 v58, v54, v10
    v_min_u32 v45, s58, v45
    v_mul_u32_u24 v55, s56, v45
    v_lshrrev_b32 v55, 18, v55
    v_lshl_add_u32 v55, v55, 2, s57
    ds_add_rtn_u32 v59, v55, v10
    v_min_u32 v46, s58, v46
    v_mul_u32_u24 v56, s56, v46
    v_lshrrev_b32 v56, 18, v56
    v_lshl_add_u32 v56, v56, 2, s57
    ds_add_rtn_u32 v60, v56, v10
    v_min_u32 v47, s58, v47
    v_mul_u32_u24 v57, s56, v47
    v_lshrrev_b32 v57, 18, v57
    v_lshl_add_u32 v57, v57, 2, s57
    ds_add_rtn_u32 v61, v57, v10
    s_mov_b64 exec, 1
    ds_add_u32 v42, v10 offset:40
    s_mov_b64 exec, -1
    s_mov_b32 s60, 0
L_ls_1:
    ds_read_b32 v43, v42 offset:40
    s_add_u32 s60, s60, 1
    s_waitcnt lgkmcnt(0)
    v_readfirstlane_b32 s61, v43
    s_cmp_ge_u32 s61, 7
    s_cbranch_scc1 L_lsok_2
    s_cmp_lt_u32 s60, 1048576
    s_cbranch_scc1 L_ls_1
L_lsok_2:
    ds_read_b128 v[64:67], v11
    s_waitcnt vmcnt(0)
    v_min_u32 v48, s58, v48
    v_and_b32 v44, 127, v44
    v_bfe_u32 v62, v48, 4, 2
    v_mad_u32_u24 v62, v62, 6, 8
    v_lshl_or_b32 v44, v44, 7, v62
    v_min_u32 v49, s58, v49
    v_and_b32 v45, 127, v45
    v_bfe_u32 v62, v49, 4, 2
    v_mad_u32_u24 v62, v62, 6, 8
    v_lshl_or_b32 v45, v45, 7, v62
    v_min_u32 v50, s58, v50
    v_and_b32 v46, 127, v46
    v_bfe_u32 v62, v50, 4, 2
    v_mad_u32_u24 v62, v62, 6, 8
    v_lshl_or_b32 v46, v46, 7, v62
    v_min_u32 v51, s58, v51
    v_and_b32 v47, 127, v47
    v_bfe_u32 v62, v51, 4, 2
    v_mad_u32_u24 v62, v62, 6, 8
    v_lshl_or_b32 v47, v47, 7, v62
    s_waitcnt lgkmcnt(0)
    v_add_u32 v69, v64, v65
    v_add_u32 v70, v69, v66
    v_add_u32 v72, v70, v67
    v_mov_b32 v73, v72
    v_lshl_or_b32 v48, v52, 16, v48
    v_and_or_b32 v49, v52, s26, v49
    v_add_u32_dpp v73, v73, v73 row_shr:1 row_mask:0xf bank_mask:0xf bound_ctrl:0
    v_lshl_or_b32 v50, v53, 16, v50
    v_and_or_b32 v51, v53, s26, v51
    v_add_u32_dpp v73, v73, v73 row_shr:2 row_mask:0xf bank_mask:0xf bound_ctrl:0
    s_nop 1
    v_add_u32_dpp v73, v73, v73 row_shr:4 row_mask:0xf bank_mask:0xf bound_ctrl:0
    s_nop 1
    v_add_u32_dpp v73, v73, v73 row_shr:8 row_mask:0xf bank_mask:0xf bound_ctrl:0
    s_nop 1
    v_add_u32_dpp v73, v73, v73 row_bcast:15 row_mask:0xa bank_mask:0xf
    s_nop 1
    v_add_u32_dpp v73, v73, v73 row_bcast:31 row_mask:0xc bank_mask:0xf
    v_sub_u32 v76, v73, v72
    v_add_u32 v77, v76, v64
    v_add_u32 v78, v76, v69
    v_add_u32 v79, v76, v70
    ds_write_b128 v11, v[76:79] offset:1024
    s_mov_b64 exec, s[96:97]
    ds_read_b32 v54, v54 offset:1024
    ds_read_b32 v55, v55 offset:1024
    ds_read_b32 v56, v56 offset:1024
    ds_read_b32 v57, v57 offset:1024
    s_mov_b32 s57, 118784
    v_lshl_add_u32 v58, v58, 3, s57
    v_lshl_add_u32 v59, v59, 3, s57
    v_lshl_add_u32 v60, v60, 3, s57
    v_lshl_add_u32 v61, v61, 3, s57
    s_waitcnt lgkmcnt(3)
    v_lshl_add_u32 v54, v54, 3, v58
    ds_write2_b32 v54, v48, v44 offset0:0 offset1:1
    s_waitcnt lgkmcnt(3)
    v_lshl_add_u32 v55, v55, 3, v59
    ds_write2_b32 v55, v49, v45 offset0:0 offset1:1
    s_waitcnt lgkmcnt(3)
    v_lshl_add_u32 v56, v56, 3, v60
    ds_write2_b32 v56, v50, v46 offset0:0 offset1:1
    s_waitcnt lgkmcnt(3)
    v_lshl_add_u32 v57, v57, 3, v61
    ds_write2_b32 v57, v51, v47 offset0:0 offset1:1
    s_mov_b64 exec, -1
    v_lshl_add_u32 v12, v1, 4, s57
    v_lshlrev_b32 v13, 4, v1
    s_mul_i32 s56, s2, 12544
    s_add_u32 s56, s56, 263192576
    s_add_u32 s57, s56, 7168
    v_cmp_gt_u32 vcc, 334, v1
    s_mov_b64 exec, 1
    ds_add_u32 v42, v10 offset:44
    s_mov_b64 exec, -1
    s_mov_b32 s60, 0
L_ls_3:
    ds_read_b32 v43, v42 offset:44
    s_add_u32 s60, s60, 1
    s_waitcnt lgkmcnt(0)
    v_readfirstlane_b32 s61, v43
    s_cmp_ge_u32 s61, 7
    s_cbranch_scc1 L_lsok_4
    s_cmp_lt_u32 s60, 1048576
    s_cbranch_scc1 L_ls_3
L_lsok_4:
    ds_read_b128 v[84:87], v12
    ds_read_b128 v[88:91], v12 offset:7168
    v_lshl_or_b32 v80, v64, 16, v76
    v_lshl_or_b32 v81, v65, 16, v77
    v_lshl_or_b32 v82, v66, 16, v78
    v_lshl_or_b32 v83, v67, 16, v79
    s_waitcnt lgkmcnt(1)
    buffer_store_dwordx4 v[84:87], v13, s[44:47], s56 offen sc1
    s_cbranch_vccz L_nost2
    s_mov_b64 exec, vcc
    s_waitcnt lgkmcnt(0)
    buffer_store_dwordx4 v[88:91], v13, s[44:47], s57 offen sc1
    s_branch L_st3
L_nost2:
    buffer_store_dwordx4 v[80:83], v14, s[44:47], s99 offen sc1
L_st3:
    s_mov_b64 exec, 1
    s_waitcnt vmcnt(0) lgkmcnt(0)
    ds_add_rtn_u32 v15, v42, v10 offset:0
    s_mov_b64 exec, -1
    s_waitcnt lgkmcnt(0)
    v_readfirstlane_b32 s58, v15
    s_cmp_lg_u32 s58, 6
    s_cbranch_scc1 L_B0
    s_mov_b64 exec, 0xff
    v_lshlrev_b32 v13, 10, v0
    v_mov_b32 v14, 1
    s_lshl_b32 s56, s2, 4
    s_and_b32 s56, s56, 0x380
    s_add_u32 s56, s56, 266862592
    buffer_atomic_add v14, v13, s[44:47], s56 offen sc1
    s_branch L_B0
L_W15cont:
    s_mov_b64 exec, -1
    v_lshlrev_b32 v1, 4, v0
    s_mov_b32 s28, s10
    s_mov_b32 s29, s11
    s_mov_b32 s32, s8
    s_mov_b32 s33, s9
    s_mov_b32 s44, s24
    s_mov_b32 s45, s25
    s_mov_b32 s36, s6
    s_mov_b32 s37, s7
    s_mov_b32 s40, s24
    s_and_b32 s41, s25, 0xffff
    s_or_b32 s41, s41, 0x00100000
    s_mov_b32 s42, 64
    s_mov_b32 s43, 0x00800000
    v_lshrrev_b32 v27, 1, v0
    s_lshl_b32 s56, s62, 5
    v_add_u32 v27, s56, v27
    v_lshlrev_b32 v25, 10, v27
    s_lshl_b32 s98, s53, 2
    s_add_u32 s98, s98, 266600448
    s_setprio 2
    s_mov_b32 s56, 0xbfb8aa3b
    s_mov_b32 s57, 0xbfb8aa3b
    s_waitcnt vmcnt(0)
    v_add_u32 v53, 32, v53
    v_readfirstlane_b32 s100, v55
    s_sub_u32 s101, s100, 1
    s_cmp_lt_u32 s100, 256
    s_cselect_b32 s100, 256, s101
    v_lshlrev_b32 v4, 16, v36
    v_and_b32 v5, s26, v36
    v_lshlrev_b32 v6, 16, v37
    v_and_b32 v7, s26, v37
    v_lshlrev_b32 v32, 16, v38
    v_and_b32 v33, s26, v38
    v_lshlrev_b32 v34, 16, v39
    v_and_b32 v35, s26, v39
    v_pk_mul_f32 v[4:5], v[4:5], s[56:57]
    v_pk_mul_f32 v[6:7], v[6:7], s[56:57]
    v_pk_mul_f32 v[32:33], v[32:33], s[56:57]
    v_pk_mul_f32 v[34:35], v[34:35], s[56:57]
    ds_write_b128 v1, v[4:7] offset:2048
    ds_write_b128 v1, v[32:35] offset:3072
L_B0:
    s_mov_b64 exec, -1
    s_mov_b32 s28, s12
    s_mov_b32 s29, s13
    s_mov_b32 s30, 131584
    s_mov_b32 s31, 0x00020000
    v_lshrrev_b32 v16, 2, v0
    v_lshlrev_b32 v16, 9, v16
    v_lshrrev_b32 v17, 5, v0
    v_lshlrev_b32 v17, 1, v17
    v_and_b32 v18, 3, v0
    v_xor_b32 v17, v17, v18
    v_lshl_add_u32 v16, v17, 4, v16
    s_lshl_b32 s56, s62, 6
    v_add_u32 v16, s56, v16
    s_mul_i32 s59, s62, 14336
    s_add_u32 s59, s59, 4096
    s_mov_b32 s58, 0
L_spin_5:
    ds_read_b32 v43, v42 offset:32
    s_add_u32 s58, s58, 1
    s_waitcnt lgkmcnt(0)
    v_readfirstlane_b32 s57, v43
    s_cmp_ge_u32 s57, 8
    s_cbranch_scc1 L_wb0
    s_sleep 2
    s_cmp_lt_u32 s58, 1048576
    s_cbranch_scc1 L_spin_5
L_wb0:
    s_add_u32 m0, s59, 8192
    s_mov_b32 s56, 65536
    buffer_load_dwordx4 v16, s[28:31], s56 offen lds
    s_add_u32 m0, m0, 1024
    s_add_u32 s56, s56, 8192
    buffer_load_dwordx4 v16, s[28:31], s56 offen lds
    s_add_u32 m0, m0, 1024
    s_add_u32 s56, s56, 8192
    buffer_load_dwordx4 v16, s[28:31], s56 offen lds
    s_add_u32 m0, m0, 1024
    s_add_u32 s56, s56, 8192
    buffer_load_dwordx4 v16, s[28:31], s56 offen lds
    s_add_u32 m0, m0, 1024
    s_add_u32 s56, s56, 8192
    buffer_load_dwordx4 v16, s[28:31], s56 offen lds
    s_add_u32 m0, m0, 1024
    s_add_u32 s56, s56, 8192
    buffer_load_dwordx4 v16, s[28:31], s56 offen lds
    s_lshl_b32 s64, s62, 11
    s_add_u32 s64, s64, 118784
    s_cmp_eq_u32 s62, 7
    s_cselect_b32 s64, 158976, s64
    v_and_b32 v19, 1, v0
    v_lshlrev_b32 v19, 1, v19
    s_movk_i32 s57, 12544
    v_mul_u32_u24 v10, s57, v27
    v_lshl_add_u32 v10, v19, 3, v10
    s_mov_b32 s22, 0
    s_cmp_eq_u32 s3, 0
    s_cselect_b32 s22, 0x302e221c, s22
    s_cmp_eq_u32 s3, 1
    s_cselect_b32 s22, 0x2d1d01, s22
    s_cmp_eq_u32 s3, 2
    s_cselect_b32 s22, 0x25130a, s22
    s_cmp_eq_u32 s3, 3
    s_cselect_b32 s22, 0x2a1803, s22
    s_cmp_eq_u32 s3, 4
    s_cselect_b32 s22, 0x2f2700, s22
    s_cmp_eq_u32 s3, 5
    s_cselect_b32 s22, 0x201909, s22
    s_cmp_eq_u32 s3, 6
    s_cselect_b32 s22, 0x2c1702, s22
    s_cmp_eq_u32 s3, 7
    s_cselect_b32 s22, 0x2b1404, s22
    s_cmp_eq_u32 s3, 8
    s_cselect_b32 s22, 0x1e1a08, s22
    s_cmp_eq_u32 s3, 9
    s_cselect_b32 s22, 0x281506, s22
    s_cmp_eq_u32 s3, 10
    s_cselect_b32 s22, 0x211f05, s22
    s_cmp_eq_u32 s3, 11
    s_cselect_b32 s22, 0x26120b, s22
    s_cmp_eq_u32 s3, 12
    s_cselect_b32 s22, 0x240f0c, s22
    s_cmp_eq_u32 s3, 13
    s_cselect_b32 s22, 0x291007, s22
    s_cmp_eq_u32 s3, 14
    s_cselect_b32 s22, 0x23110d, s22
    s_cmp_eq_u32 s3, 15
    s_cselect_b32 s22, 0x1b160e, s22
    v_mul_u32_u24 v33, 43, v0
    v_lshrrev_b32 v33, 7, v33
    v_mul_u32_u24 v34, 24, v33
    v_lshlrev_b32 v32, 3, v0
    v_sub_u32 v32, v32, v34
    v_cmp_lt_u32 vcc, 14, v0
    s_nop 1
    v_cndmask_b32 v32, v32, 24, vcc
    v_bfe_u32 v32, s22, v32, 8
    v_lshlrev_b32 v32, 3, v32
    v_mad_u32_u24 v33, v33, 6, 8
    v_subrev_u32 v34, 6, v33
    v_min_u32 v33, 26, v33
    v_min_u32 v34, 26, v34
    s_mov_b32 s56, 48912210
    v_lshl_add_u32 v35, v0, 26, s56
    v_lshrrev_b32 v43, 5, v0
    s_bfe_u32 s56, s22, 0x80000
    s_bfe_u32 s57, s22, 0x80008
    s_bfe_u32 s58, s22, 0x80010
    s_lshl_b32 s56, s56, 3
    s_lshl_b32 s57, s57, 3
    s_lshl_b32 s58, s58, 3
    v_lshl_add_u32 v36, v43, 2, s56
    v_lshl_add_u32 v37, v43, 2, s57
    v_lshl_add_u32 v38, v43, 2, s58
    v_bfe_u32 v43, v0, 2, 3
    v_mul_u32_u24 v39, 14336, v43
    v_and_b32 v43, 3, v0
    v_lshl_add_u32 v39, v43, 5, v39
    v_and_b32 v43, 4, v0
    v_lshl_add_u32 v39, v43, 2, v39
    v_and_b32 v43, 8, v0
    v_lshl_add_u32 v39, v43, 4, v39
    v_add_u32 v39, 22384, v39
    s_lshl_b32 s56, s3, 6
    v_and_b32 v40, 60, v0
    v_add_u32 v40, s56, v40
    s_mov_b32 s58, 0
L_spin_6:
    ds_read_b32 v43, v42 offset:0
    s_add_u32 s58, s58, 1
    s_waitcnt lgkmcnt(0)
    v_readfirstlane_b32 s57, v43
    s_cmp_ge_u32 s57, 7
    s_cbranch_scc1 L_own
    s_sleep 1
    s_cmp_lt_u32 s58, 1048576
    s_cbranch_scc1 L_spin_6
L_own:
    s_add_u32 m0, s64, 0
    s_mov_b32 s56, 114688
    buffer_load_dwordx4 v16, s[28:31], s56 offen lds
    s_add_u32 m0, m0, 1024
    s_add_u32 s56, s56, 8192
    buffer_load_dwordx4 v16, s[28:31], s56 offen lds
    v_mov_b32 v17, 1
    s_mov_b64 exec, 1
    s_waitcnt vmcnt(0)
    ds_add_u32 v42, v17 offset:48
    s_mov_b64 exec, -1
    s_cmp_eq_u32 s3, 15
    s_cbranch_scc1 L_w15b
    s_mov_b64 exec, 0
    s_cmp_eq_u32 s3, 8
    s_cbranch_scc1 L_stub0
    s_cmp_eq_u32 s3, 9
    s_cbranch_scc1 L_stub5
    s_cmp_eq_u32 s3, 10
    s_cbranch_scc1 L_stub6
    s_cmp_eq_u32 s3, 11
    s_cbranch_scc1 L_stub7
    s_cmp_eq_u32 s3, 12
    s_cbranch_scc1 L_stub8
    s_cmp_eq_u32 s3, 13
    s_cbranch_scc1 L_stub9
    s_cmp_eq_u32 s3, 14
    s_cbranch_scc1 L_stub10
L_Bback:
    s_mov_b64 exec, -1
    s_mov_b32 s58, 0
L_spin_7:
    ds_read_b32 v43, v42 offset:8
    s_add_u32 s58, s58, 1
    s_waitcnt lgkmcnt(0)
    v_readfirstlane_b32 s57, v43
    s_cmp_lg_u32 s57, 0
    s_cbranch_scc1 L_goseen
    s_sleep 2
    s_cmp_lt_u32 s58, 1048576
    s_cbranch_scc1 L_spin_7
L_goseen:
    s_cmp_eq_u32 s57, 1
    s_cbranch_scc1 L_offok
L_B0_to:
    s_mov_b64 exec, -1
    v_mov_b32 v43, 2
    ds_or_b32 v42, v43 offset:12
    s_mov_b32 s63, 0
    s_branch L_B1done
L_w15b:
    s_sleep 8
    s_mov_b64 exec, 0xff
    s_mov_b32 s58, 0
L_offp:
    buffer_load_dword v18, v52, s[44:47], s23 offen sc1
    s_add_u32 s58, s58, 1
    s_waitcnt vmcnt(0)
    v_cmp_ne_u32 vcc, v18, v53
    s_nop 0
    s_cbranch_vccz L_go
    s_mov_b64 exec, vcc
    s_cmp_lt_u32 s58, 6
    s_cbranch_scc1 L_dk_8
    global_load_dword v18, v42, s[0:1] sc1
    s_waitcnt vmcnt(0)
    v_readfirstlane_b32 s57, v18
    s_cmp_eq_u32 s57, s100
    s_cbranch_scc1 L_go
L_dk_8:
    s_sleep 8
    s_cmp_lt_u32 s58, 6000
    s_cbranch_scc1 L_offp
    v_mov_b32 v43, 2
    ds_or_b32 v42, v43 offset:8
    s_branch L_B0_to
L_go:
    v_mov_b32 v43, 1
    ds_or_b32 v42, v43 offset:8
    s_mov_b64 exec, -1
L_offok:
    buffer_load_dword v18, v25, s[44:47], s98 offen sc1
    s_waitcnt vmcnt(0)
    v_and_b32 v16, 0xffff, v18
    v_lshrrev_b32 v11, 16, v18
    v_lshl_add_u32 v10, v16, 3, v10
    v_cmp_lt_u32 vcc, 24, v11
    v_sub_u32 v11, v11, v19
    s_mov_b32 s56, 263192576
    s_mov_b32 s63, 0
    v_cmp_lt_i32 s[72:73], 0, v11
    s_cmp_eq_u64 s[72:73], 0
    s_cbranch_scc1 L_ldone
    s_mov_b64 exec, s[72:73]
    buffer_load_dwordx4 v[60:63], v10, s[44:47], s56 offen offset:0 sc1
    v_cmp_lt_i32 s[74:75], 1, v11
    s_add_u32 s63, s63, 1
    v_cmp_lt_i32 s[76:77], 4, v11
    s_cmp_eq_u64 s[76:77], 0
    s_cbranch_scc1 L_ldone
    s_mov_b64 exec, s[76:77]
    buffer_load_dwordx4 v[72:75], v10, s[44:47], s56 offen offset:32 sc1
    v_cmp_lt_i32 s[78:79], 5, v11
    s_add_u32 s63, s63, 1
    v_cmp_lt_i32 s[80:81], 8, v11
    s_cmp_eq_u64 s[80:81], 0
    s_cbranch_scc1 L_ldone
    s_mov_b64 exec, s[80:81]
    buffer_load_dwordx4 v[84:87], v10, s[44:47], s56 offen offset:64 sc1
    v_cmp_lt_i32 s[82:83], 9, v11
    s_add_u32 s63, s63, 1
    v_cmp_lt_i32 s[84:85], 12, v11
    s_cmp_eq_u64 s[84:85], 0
    s_cbranch_scc1 L_ldone
    s_mov_b64 exec, s[84:85]
    buffer_load_dwordx4 v[96:99], v10, s[44:47], s56 offen offset:96 sc1
    v_cmp_lt_i32 s[86:87], 13, v11
    s_add_u32 s63, s63, 1
    v_cmp_lt_i32 s[88:89], 16, v11
    s_cmp_eq_u64 s[88:89], 0
    s_cbranch_scc1 L_ldone
    s_mov_b64 exec, s[88:89]
    buffer_load_dwordx4 v[108:111], v10, s[44:47], s56 offen offset:128 sc1
    v_cmp_lt_i32 s[90:91], 17, v11
    s_add_u32 s63, s63, 1
    v_cmp_lt_i32 s[92:93], 20, v11
    s_cmp_eq_u64 s[92:93], 0
    s_cbranch_scc1 L_ldone
    s_mov_b64 exec, s[92:93]
    buffer_load_dwordx4 v[120:123], v10, s[44:47], s56 offen offset:160 sc1
    v_cmp_lt_i32 s[94:95], 21, v11
    s_add_u32 s63, s63, 1
L_ldone:
    s_mov_b64 exec, -1
    s_cbranch_vccz L_noovf
    v_mov_b32 v43, 1
    ds_or_b32 v42, v43 offset:12
L_noovf:
    s_lshl_b32 s57, s51, 7
    v_mov_b32 v16, 0x41041
    s_waitcnt vmcnt(0)
    s_cmp_le_u32 s63, 0
    s_cbranch_scc1 L_B1done
    s_mov_b64 exec, s[72:73]
    v_subrev_u32 v64, s57, v61
    v_lshlrev_b32 v20, v61, v16
    v_bfe_u32 v64, v64, 5, 9
    ds_add_rtn_u32 v65, v64, v20 offset:256
    s_mov_b64 exec, s[74:75]
    v_subrev_u32 v66, s57, v63
    v_lshlrev_b32 v21, v63, v16
    v_bfe_u32 v66, v66, 5, 9
    ds_add_rtn_u32 v67, v66, v21 offset:256
    s_cmp_le_u32 s63, 1
    s_cbranch_scc1 L_B1done
    s_mov_b64 exec, s[76:77]
    v_subrev_u32 v76, s57, v73
    v_lshlrev_b32 v20, v73, v16
    v_bfe_u32 v76, v76, 5, 9
    ds_add_rtn_u32 v77, v76, v20 offset:256
    s_mov_b64 exec, s[78:79]
    v_subrev_u32 v78, s57, v75
    v_lshlrev_b32 v21, v75, v16
    v_bfe_u32 v78, v78, 5, 9
    ds_add_rtn_u32 v79, v78, v21 offset:256
    s_cmp_le_u32 s63, 2
    s_cbranch_scc1 L_B1done
    s_mov_b64 exec, s[80:81]
    v_subrev_u32 v88, s57, v85
    v_lshlrev_b32 v20, v85, v16
    v_bfe_u32 v88, v88, 5, 9
    ds_add_rtn_u32 v89, v88, v20 offset:256
    s_mov_b64 exec, s[82:83]
    v_subrev_u32 v90, s57, v87
    v_lshlrev_b32 v21, v87, v16
    v_bfe_u32 v90, v90, 5, 9
    ds_add_rtn_u32 v91, v90, v21 offset:256
    s_cmp_le_u32 s63, 3
    s_cbranch_scc1 L_B1done
    s_mov_b64 exec, s[84:85]
    v_subrev_u32 v100, s57, v97
    v_lshlrev_b32 v20, v97, v16
    v_bfe_u32 v100, v100, 5, 9
    ds_add_rtn_u32 v101, v100, v20 offset:256
    s_mov_b64 exec, s[86:87]
    v_subrev_u32 v102, s57, v99
    v_lshlrev_b32 v21, v99, v16
    v_bfe_u32 v102, v102, 5, 9
    ds_add_rtn_u32 v103, v102, v21 offset:256
    s_cmp_le_u32 s63, 4
    s_cbranch_scc1 L_B1done
    s_mov_b64 exec, s[88:89]
    v_subrev_u32 v112, s57, v109
    v_lshlrev_b32 v20, v109, v16
    v_bfe_u32 v112, v112, 5, 9
    ds_add_rtn_u32 v113, v112, v20 offset:256
    s_mov_b64 exec, s[90:91]
    v_subrev_u32 v114, s57, v111
    v_lshlrev_b32 v21, v111, v16
    v_bfe_u32 v114, v114, 5, 9
    ds_add_rtn_u32 v115, v114, v21 offset:256
    s_cmp_le_u32 s63, 5
    s_cbranch_scc1 L_B1done
    s_mov_b64 exec, s[92:93]
    v_subrev_u32 v124, s57, v121
    v_lshlrev_b32 v20, v121, v16
    v_bfe_u32 v124, v124, 5, 9
    ds_add_rtn_u32 v125, v124, v20 offset:256
    s_mov_b64 exec, s[94:95]
    v_subrev_u32 v126, s57, v123
    v_lshlrev_b32 v21, v123, v16
    v_bfe_u32 v126, v126, 5, 9
    ds_add_rtn_u32 v127, v126, v21 offset:256
L_B1done:
    s_mov_b64 exec, -1
    s_setprio 0
    s_waitcnt lgkmcnt(0)
L_stub0:
    s_cbranch_execz L_stub11
    s_barrier
    s_mov_b32 s57, 118784
    v_mov_b32 v20, 0
    s_cmp_lg_u32 s3, 15
    s_cbranch_scc1 L_nopre
    s_setprio 3
L_nopre:
    s_cmp_le_u32 s63, 0
    s_cbranch_scc1 L_sc2
    s_mov_b64 exec, s[72:73]
    ds_read_b32 v4, v64 offset:256
    v_max_u32 v20, v20, v65
    v_mad_u32_u24 v64, v64, 46, s57
    s_mov_b64 exec, s[74:75]
    ds_read_b32 v5, v66 offset:256
    v_max_u32 v20, v20, v67
    v_mad_u32_u24 v66, v66, 46, s57
    s_cmp_le_u32 s63, 1
    s_cbranch_scc1 L_sc2
    s_mov_b64 exec, s[76:77]
    ds_read_b32 v6, v76 offset:256
    v_max_u32 v20, v20, v77
    v_mad_u32_u24 v76, v76, 46, s57
    s_mov_b64 exec, s[78:79]
    ds_read_b32 v7, v78 offset:256
    v_max_u32 v20, v20, v79
    v_mad_u32_u24 v78, v78, 46, s57
    s_cmp_le_u32 s63, 2
    s_cbranch_scc1 L_sc2
    s_mov_b64 exec, s[80:81]
    ds_read_b32 v8, v88 offset:256
    v_max_u32 v20, v20, v89
    v_mad_u32_u24 v88, v88, 46, s57
    s_mov_b64 exec, s[82:83]
    ds_read_b32 v9, v90 offset:256
    v_max_u32 v20, v20, v91
    v_mad_u32_u24 v90, v90, 46, s57
    s_cmp_le_u32 s63, 3
    s_cbranch_scc1 L_sc2
    s_mov_b64 exec, s[84:85]
    ds_read_b32 v10, v100 offset:256
    v_max_u32 v20, v20, v101
    v_mad_u32_u24 v100, v100, 46, s57
    s_mov_b64 exec, s[86:87]
    ds_read_b32 v11, v102 offset:256
    v_max_u32 v20, v20, v103
    v_mad_u32_u24 v102, v102, 46, s57
    s_cmp_le_u32 s63, 4
    s_cbranch_scc1 L_sc2
    s_mov_b64 exec, s[88:89]
    ds_read_b32 v12, v112 offset:256
    v_max_u32 v20, v20, v113
    v_mad_u32_u24 v112, v112, 46, s57
    s_mov_b64 exec, s[90:91]
    ds_read_b32 v13, v114 offset:256
    v_max_u32 v20, v20, v115
    v_mad_u32_u24 v114, v114, 46, s57
    s_cmp_le_u32 s63, 5
    s_cbranch_scc1 L_sc2
    s_mov_b64 exec, s[92:93]
    ds_read_b32 v14, v124 offset:256
    v_max_u32 v20, v20, v125
    v_mad_u32_u24 v124, v124, 46, s57
    s_mov_b64 exec, s[94:95]
    ds_read_b32 v15, v126 offset:256
    v_max_u32 v20, v20, v127
    v_mad_u32_u24 v126, v126, 46, s57
L_sc2:
    s_mov_b64 exec, -1
    s_waitcnt lgkmcnt(0)
    s_cmp_le_u32 s63, 0
    s_cbranch_scc1 L_sc3
    s_mov_b64 exec, s[72:73]
    v_sub_u32 v4, v4, v65
    v_lshl_add_u32 v4, v4, 6, v65
    v_bfe_u32 v4, v4, v61, 6
    v_lshl_add_u32 v4, v4, 2, v64
    ds_write_b32 v4, v60
    s_mov_b64 exec, s[74:75]
    v_sub_u32 v5, v5, v67
    v_lshl_add_u32 v5, v5, 6, v67
    v_bfe_u32 v5, v5, v63, 6
    v_lshl_add_u32 v5, v5, 2, v66
    ds_write_b32 v5, v62
    s_cmp_le_u32 s63, 1
    s_cbranch_scc1 L_sc3
    s_mov_b64 exec, s[76:77]
    v_sub_u32 v6, v6, v77
    v_lshl_add_u32 v6, v6, 6, v77
    v_bfe_u32 v6, v6, v73, 6
    v_lshl_add_u32 v6, v6, 2, v76
    ds_write_b32 v6, v72
    s_mov_b64 exec, s[78:79]
    v_sub_u32 v7, v7, v79
    v_lshl_add_u32 v7, v7, 6, v79
    v_bfe_u32 v7, v7, v75, 6
    v_lshl_add_u32 v7, v7, 2, v78
    ds_write_b32 v7, v74
    s_cmp_le_u32 s63, 2
    s_cbranch_scc1 L_sc3
    s_mov_b64 exec, s[80:81]
    v_sub_u32 v8, v8, v89
    v_lshl_add_u32 v8, v8, 6, v89
    v_bfe_u32 v8, v8, v85, 6
    v_lshl_add_u32 v8, v8, 2, v88
    ds_write_b32 v8, v84
    s_mov_b64 exec, s[82:83]
    v_sub_u32 v9, v9, v91
    v_lshl_add_u32 v9, v9, 6, v91
    v_bfe_u32 v9, v9, v87, 6
    v_lshl_add_u32 v9, v9, 2, v90
    ds_write_b32 v9, v86
    s_cmp_le_u32 s63, 3
    s_cbranch_scc1 L_sc3
    s_mov_b64 exec, s[84:85]
    v_sub_u32 v10, v10, v101
    v_lshl_add_u32 v10, v10, 6, v101
    v_bfe_u32 v10, v10, v97, 6
    v_lshl_add_u32 v10, v10, 2, v100
    ds_write_b32 v10, v96
    s_mov_b64 exec, s[86:87]
    v_sub_u32 v11, v11, v103
    v_lshl_add_u32 v11, v11, 6, v103
    v_bfe_u32 v11, v11, v99, 6
    v_lshl_add_u32 v11, v11, 2, v102
    ds_write_b32 v11, v98
    s_cmp_le_u32 s63, 4
    s_cbranch_scc1 L_sc3
    s_mov_b64 exec, s[88:89]
    v_sub_u32 v12, v12, v113
    v_lshl_add_u32 v12, v12, 6, v113
    v_bfe_u32 v12, v12, v109, 6
    v_lshl_add_u32 v12, v12, 2, v112
    ds_write_b32 v12, v108
    s_mov_b64 exec, s[90:91]
    v_sub_u32 v13, v13, v115
    v_lshl_add_u32 v13, v13, 6, v115
    v_bfe_u32 v13, v13, v111, 6
    v_lshl_add_u32 v13, v13, 2, v114
    ds_write_b32 v13, v110
    s_cmp_le_u32 s63, 5
    s_cbranch_scc1 L_sc3
    s_mov_b64 exec, s[92:93]
    v_sub_u32 v14, v14, v125
    v_lshl_add_u32 v14, v14, 6, v125
    v_bfe_u32 v14, v14, v121, 6
    v_lshl_add_u32 v14, v14, 2, v124
    ds_write_b32 v14, v120
    s_mov_b64 exec, s[94:95]
    v_sub_u32 v15, v15, v127
    v_lshl_add_u32 v15, v15, 6, v127
    v_bfe_u32 v15, v15, v123, 6
    v_lshl_add_u32 v15, v15, 2, v126
    ds_write_b32 v15, v122
L_sc3:
    s_mov_b64 exec, -1
    v_cmp_le_u32 vcc, 0xb8000000, v20
    s_nop 0
    s_cbranch_vccz L_C2
    v_mov_b32 v43, 1
    ds_or_b32 v42, v43 offset:12
    s_branch L_C2
L_stub1:
    s_branch L_stub2
L_Gcont:
    s_mov_b32 s23, 0
    s_mov_b32 s44, s24
    s_mov_b32 s45, s25
    s_mov_b32 s36, s6
    s_mov_b32 s37, s7
    s_mov_b32 s40, s24
    s_and_b32 s41, s25, 0xffff
    s_or_b32 s41, s41, 0x00100000
    s_mov_b32 s42, 64
    s_mov_b32 s43, 0x00800000
    v_lshrrev_b32 v4, 4, v0
    v_bfe_u32 v5, v0, 2, 2
    v_lshl_add_u32 v5, v4, 3, v5
    v_lshlrev_b32 v2, 6, v5
    v_lshl_add_u32 v2, v3, 3, v2
    v_and_b32 v5, 1, v4
    v_lshl_add_u32 v2, v5, 5, v2
    v_add_u32 v2, s59, v2
    v_xor_b32 v3, 32, v2
    v_and_b32 v5, 15, v0
    v_xor_b32 v6, v4, v5
    v_lshlrev_b32 v6, 4, v6
    v_lshl_add_u32 v16, v5, 8, v6
    v_add_u32 v16, 133376, v16
    v_xor_b32 v17, 64, v16
    v_xor_b32 v18, 0x80, v16
    v_xor_b32 v19, 0xc0, v16
    v_lshlrev_b32 v6, 9, v5
    v_lshl_add_u32 v6, v4, 4, v6
    s_lshl_b32 s56, s3, 6
    v_add_u32 v6, s56, v6
    v_mul_u32_u24 v7, 144, v5
    v_lshl_add_u32 v7, v4, 5, v7
    s_and_b32 s56, s3, 1
    s_lshl_b32 s56, s56, 4
    s_and_b32 s57, s3, 2
    s_lshl_b32 s57, s57, 6
    s_add_u32 s56, s56, s57
    s_add_u32 s56, s56, s59
    v_add_u32 v7, s56, v7
    s_mov_b32 s32, s24
    s_mov_b32 s33, s25
    s_lshl_b32 s34, s50, 9
    s_add_u32 s34, s34, 249561600
    s_mov_b32 s35, 0x00020000
    s_mov_b32 s92, 0xbfb8aa3b
    s_lshl_b32 s60, s49, 9
    s_add_u32 s60, s60, 249561600
    s_lshl_b32 s64, s3, 11
    s_add_u32 s64, s64, 118784
    s_cmp_eq_u32 s3, 7
    s_cselect_b32 s64, 158976, s64
    s_sub_u32 s56, s64, s59
    v_add_u32 v20, s56, v2
    v_add_u32 v21, s56, v3
    s_add_u32 s63, s54, 1
    s_lshl_b32 s63, s63, 3
    v_mov_b32 v4, 1
    s_mov_b64 exec, 1
    s_waitcnt vmcnt(0)
    ds_add_u32 v42, v4 offset:32
    s_mov_b64 exec, -1
    s_mov_b32 s58, 0
L_spin_9:
    ds_read_b32 v43, v42 offset:32
    s_add_u32 s58, s58, 1
    s_waitcnt lgkmcnt(0)
    v_readfirstlane_b32 s56, v43
    s_cmp_ge_u32 s56, s63
    s_cbranch_scc1 L_xok
    s_sleep 1
    s_cmp_lt_u32 s58, 1048576
    s_cbranch_scc1 L_spin_9
L_xok:
    ds_read_b64_tr_b16 v[96:97], v2 offset:0
    ds_read_b64_tr_b16 v[98:99], v2 offset:256
    ds_read_b64_tr_b16 v[112:113], v3 offset:0
    ds_read_b64_tr_b16 v[114:115], v3 offset:256
    ds_read_b64_tr_b16 v[100:101], v2 offset:2048
    ds_read_b64_tr_b16 v[102:103], v2 offset:2304
    ds_read_b64_tr_b16 v[116:117], v3 offset:2048
    ds_read_b64_tr_b16 v[118:119], v3 offset:2304
    ds_read_b64_tr_b16 v[104:105], v2 offset:4096
    ds_read_b64_tr_b16 v[106:107], v2 offset:4352
    ds_read_b64_tr_b16 v[120:121], v3 offset:4096
    ds_read_b64_tr_b16 v[122:123], v3 offset:4352
    ds_read_b64_tr_b16 v[108:109], v2 offset:6144
    ds_read_b64_tr_b16 v[110:111], v2 offset:6400
    ds_read_b64_tr_b16 v[124:125], v3 offset:6144
    ds_read_b64_tr_b16 v[126:127], v3 offset:6400
    ds_read_b128 v[44:47], v16 offset:0
    ds_read_b128 v[48:51], v17 offset:0
    ds_read_b128 v[52:55], v18 offset:0
    ds_read_b128 v[56:59], v19 offset:0
    s_cmp_eq_u32 s54, 0
    s_cbranch_scc1 L_nowb
    s_add_u32 m0, s59, 8192
    s_mov_b32 s56, 65536
    buffer_load_dwordx4 v1, s[28:31], s56 offen lds
    s_add_u32 m0, m0, 1024
    s_add_u32 s56, s56, 8192
    buffer_load_dwordx4 v1, s[28:31], s56 offen lds
    s_add_u32 m0, m0, 1024
    s_add_u32 s56, s56, 8192
    buffer_load_dwordx4 v1, s[28:31], s56 offen lds
    s_add_u32 m0, m0, 1024
    s_add_u32 s56, s56, 8192
    buffer_load_dwordx4 v1, s[28:31], s56 offen lds
    s_add_u32 m0, m0, 1024
    s_add_u32 s56, s56, 8192
    buffer_load_dwordx4 v1, s[28:31], s56 offen lds
    s_add_u32 m0, m0, 1024
    s_add_u32 s56, s56, 8192
    buffer_load_dwordx4 v1, s[28:31], s56 offen lds
    s_add_u32 m0, s64, 0
    s_mov_b32 s56, 114688
    buffer_load_dwordx4 v1, s[28:31], s56 offen lds
    s_add_u32 m0, m0, 1024
    s_add_u32 s56, s56, 8192
    buffer_load_dwordx4 v1, s[28:31], s56 offen lds
    s_waitcnt vmcnt(0)
L_nowb:
    s_setprio 1
    s_waitcnt lgkmcnt(0)
    v_mfma_f32_16x16x32_bf16 v[8:11], v[96:99], v[44:47], 0
    ds_read_b128 v[68:71], v16 offset:4096
    ds_read_b128 v[80:83], v17 offset:4096
    v_mfma_f32_16x16x32_bf16 v[12:15], v[112:115], v[44:47], 0
    ds_read_b128 v[88:91], v18 offset:4096
    ds_read_b128 v[92:95], v19 offset:4096
    v_mfma_f32_16x16x32_bf16 v[8:11], v[100:103], v[48:51], v[8:11]
    v_mfma_f32_16x16x32_bf16 v[12:15], v[116:119], v[48:51], v[12:15]
    v_mfma_f32_16x16x32_bf16 v[8:11], v[104:107], v[52:55], v[8:11]
    v_mfma_f32_16x16x32_bf16 v[12:15], v[120:123], v[52:55], v[12:15]
    v_mfma_f32_16x16x32_bf16 v[8:11], v[108:111], v[56:59], v[8:11]
    v_mfma_f32_16x16x32_bf16 v[12:15], v[124:127], v[56:59], v[12:15]
    s_waitcnt lgkmcnt(0)
    v_mfma_f32_16x16x32_bf16 v[24:27], v[96:99], v[68:71], 0
    ds_read_b128 v[44:47], v16 offset:8192
    ds_read_b128 v[48:51], v17 offset:8192
    v_mfma_f32_16x16x32_bf16 v[28:31], v[112:115], v[68:71], 0
    ds_read_b128 v[52:55], v18 offset:8192
    ds_read_b128 v[56:59], v19 offset:8192
    v_mfma_f32_16x16x32_bf16 v[24:27], v[100:103], v[80:83], v[24:27]
    v_mul_f32 v8, s92, v8
    v_mul_f32 v9, s92, v9
    v_mfma_f32_16x16x32_bf16 v[28:31], v[116:119], v[80:83], v[28:31]
    v_mul_f32 v10, s92, v10
    v_mul_f32 v11, s92, v11
    v_mfma_f32_16x16x32_bf16 v[24:27], v[104:107], v[88:91], v[24:27]
    v_cvt_pk_bf16_f32 v32, v8, v9
    v_mul_f32 v12, s92, v12
    v_mfma_f32_16x16x32_bf16 v[28:31], v[120:123], v[88:91], v[28:31]
    v_mul_f32 v13, s92, v13
    v_cvt_pk_bf16_f32 v33, v10, v11
    v_mfma_f32_16x16x32_bf16 v[24:27], v[108:111], v[92:95], v[24:27]
    v_mul_f32 v14, s92, v14
    v_mul_f32 v15, s92, v15
    v_mfma_f32_16x16x32_bf16 v[28:31], v[124:127], v[92:95], v[28:31]
    v_cvt_pk_bf16_f32 v34, v12, v13
    v_cvt_pk_bf16_f32 v35, v14, v15
    buffer_store_dwordx4 v[32:35], v6, s[32:35], s60 offen sc1
    s_add_u32 s60, s60, 8192
L_stub2:
    s_cbranch_execz L_stub3
    s_waitcnt lgkmcnt(0)
    v_mfma_f32_16x16x32_bf16 v[8:11], v[96:99], v[44:47], 0
    ds_read_b128 v[68:71], v16 offset:12288
    ds_read_b128 v[80:83], v17 offset:12288
    v_mfma_f32_16x16x32_bf16 v[12:15], v[112:115], v[44:47], 0
    ds_read_b128 v[88:91], v18 offset:12288
    ds_read_b128 v[92:95], v19 offset:12288
    v_mfma_f32_16x16x32_bf16 v[8:11], v[100:103], v[48:51], v[8:11]
    v_mul_f32 v24, s92, v24
    v_mul_f32 v25, s92, v25
    v_mfma_f32_16x16x32_bf16 v[12:15], v[116:119], v[48:51], v[12:15]
    v_mul_f32 v26, s92, v26
    v_mul_f32 v27, s92, v27
    v_mfma_f32_16x16x32_bf16 v[8:11], v[104:107], v[52:55], v[8:11]
    v_cvt_pk_bf16_f32 v36, v24, v25
    v_mul_f32 v28, s92, v28
    v_mfma_f32_16x16x32_bf16 v[12:15], v[120:123], v[52:55], v[12:15]
    v_mul_f32 v29, s92, v29
    v_cvt_pk_bf16_f32 v37, v26, v27
    v_mfma_f32_16x16x32_bf16 v[8:11], v[108:111], v[56:59], v[8:11]
    v_mul_f32 v30, s92, v30
    v_mul_f32 v31, s92, v31
    v_mfma_f32_16x16x32_bf16 v[12:15], v[124:127], v[56:59], v[12:15]
    v_cvt_pk_bf16_f32 v38, v28, v29
    v_cvt_pk_bf16_f32 v39, v30, v31
    buffer_store_dwordx4 v[36:39], v6, s[32:35], s60 offen sc1
    s_add_u32 s60, s60, 8192
    s_waitcnt lgkmcnt(0)
    v_mfma_f32_16x16x32_bf16 v[24:27], v[96:99], v[68:71], 0
    ds_read_b128 v[44:47], v16 offset:16384
    ds_read_b128 v[48:51], v17 offset:16384
    v_mfma_f32_16x16x32_bf16 v[28:31], v[112:115], v[68:71], 0
    ds_read_b128 v[52:55], v18 offset:16384
    ds_read_b128 v[56:59], v19 offset:16384
    v_mfma_f32_16x16x32_bf16 v[24:27], v[100:103], v[80:83], v[24:27]
    v_mul_f32 v8, s92, v8
    v_mul_f32 v9, s92, v9
    v_mfma_f32_16x16x32_bf16 v[28:31], v[116:119], v[80:83], v[28:31]
    v_mul_f32 v10, s92, v10
    v_mul_f32 v11, s92, v11
    v_mfma_f32_16x16x32_bf16 v[24:27], v[104:107], v[88:91], v[24:27]
    v_cvt_pk_bf16_f32 v60, v8, v9
    v_mul_f32 v12, s92, v12
    v_mfma_f32_16x16x32_bf16 v[28:31], v[120:123], v[88:91], v[28:31]
    v_mul_f32 v13, s92, v13
    v_cvt_pk_bf16_f32 v61, v10, v11
    v_mfma_f32_16x16x32_bf16 v[24:27], v[108:111], v[92:95], v[24:27]
    v_mul_f32 v14, s92, v14
    v_mul_f32 v15, s92, v15
    v_mfma_f32_16x16x32_bf16 v[28:31], v[124:127], v[92:95], v[28:31]
    v_cvt_pk_bf16_f32 v62, v12, v13
    v_cvt_pk_bf16_f32 v63, v14, v15
    buffer_store_dwordx4 v[60:63], v6, s[32:35], s60 offen sc1
    s_add_u32 s60, s60, 8192
    s_waitcnt lgkmcnt(0)
    v_mfma_f32_16x16x32_bf16 v[8:11], v[96:99], v[44:47], 0
    ds_read_b128 v[68:71], v16 offset:20480
    ds_read_b128 v[80:83], v17 offset:20480
    v_mfma_f32_16x16x32_bf16 v[12:15], v[112:115], v[44:47], 0
    ds_read_b128 v[88:91], v18 offset:20480
    ds_read_b128 v[92:95], v19 offset:20480
    v_mfma_f32_16x16x32_bf16 v[8:11], v[100:103], v[48:51], v[8:11]
    v_mul_f32 v24, s92, v24
    v_mul_f32 v25, s92, v25
    v_mfma_f32_16x16x32_bf16 v[12:15], v[116:119], v[48:51], v[12:15]
    v_mul_f32 v26, s92, v26
    v_mul_f32 v27, s92, v27
    v_mfma_f32_16x16x32_bf16 v[8:11], v[104:107], v[52:55], v[8:11]
    v_cvt_pk_bf16_f32 v64, v24, v25
    v_mul_f32 v28, s92, v28
    v_mfma_f32_16x16x32_bf16 v[12:15], v[120:123], v[52:55], v[12:15]
    v_mul_f32 v29, s92, v29
    v_cvt_pk_bf16_f32 v65, v26, v27
    v_mfma_f32_16x16x32_bf16 v[8:11], v[108:111], v[56:59], v[8:11]
    v_mul_f32 v30, s92, v30
    v_mul_f32 v31, s92, v31
    v_mfma_f32_16x16x32_bf16 v[12:15], v[124:127], v[56:59], v[12:15]
    v_cvt_pk_bf16_f32 v66, v28, v29
    v_cvt_pk_bf16_f32 v67, v30, v31
    buffer_store_dwordx4 v[64:67], v6, s[32:35], s60 offen sc1
    s_add_u32 s60, s60, 8192
    s_waitcnt lgkmcnt(0)
    v_mfma_f32_16x16x32_bf16 v[24:27], v[96:99], v[68:71], 0
    ds_read_b128 v[44:47], v16 offset:24576
    ds_read_b128 v[48:51], v17 offset:24576
    v_mfma_f32_16x16x32_bf16 v[28:31], v[112:115], v[68:71], 0
    ds_read_b128 v[52:55], v18 offset:24576
    ds_read_b128 v[56:59], v19 offset:24576
    v_mfma_f32_16x16x32_bf16 v[24:27], v[100:103], v[80:83], v[24:27]
    v_mul_f32 v8, s92, v8
    v_mul_f32 v9, s92, v9
    v_mfma_f32_16x16x32_bf16 v[28:31], v[116:119], v[80:83], v[28:31]
    v_mul_f32 v10, s92, v10
    v_mul_f32 v11, s92, v11
    v_mfma_f32_16x16x32_bf16 v[24:27], v[104:107], v[88:91], v[24:27]
    v_cvt_pk_bf16_f32 v72, v8, v9
    v_mul_f32 v12, s92, v12
    v_mfma_f32_16x16x32_bf16 v[28:31], v[120:123], v[88:91], v[28:31]
    v_mul_f32 v13, s92, v13
    v_cvt_pk_bf16_f32 v73, v10, v11
    v_mfma_f32_16x16x32_bf16 v[24:27], v[108:111], v[92:95], v[24:27]
    v_mul_f32 v14, s92, v14
    v_mul_f32 v15, s92, v15
    v_mfma_f32_16x16x32_bf16 v[28:31], v[124:127], v[92:95], v[28:31]
    v_cvt_pk_bf16_f32 v74, v12, v13
    v_cvt_pk_bf16_f32 v75, v14, v15
    buffer_store_dwordx4 v[72:75], v6, s[32:35], s60 offen sc1
    s_add_u32 s60, s60, 8192
    s_waitcnt lgkmcnt(0)
    v_mfma_f32_16x16x32_bf16 v[8:11], v[96:99], v[44:47], 0
    v_mfma_f32_16x16x32_bf16 v[12:15], v[112:115], v[44:47], 0
    v_mfma_f32_16x16x32_bf16 v[8:11], v[100:103], v[48:51], v[8:11]
    v_mul_f32 v24, s92, v24
    v_mul_f32 v25, s92, v25
    v_mfma_f32_16x16x32_bf16 v[12:15], v[116:119], v[48:51], v[12:15]
    v_mul_f32 v26, s92, v26
    v_mul_f32 v27, s92, v27
    v_mfma_f32_16x16x32_bf16 v[8:11], v[104:107], v[52:55], v[8:11]
    v_cvt_pk_bf16_f32 v76, v24, v25
    v_mul_f32 v28, s92, v28
    v_mfma_f32_16x16x32_bf16 v[12:15], v[120:123], v[52:55], v[12:15]
    v_mul_f32 v29, s92, v29
    v_cvt_pk_bf16_f32 v77, v26, v27
    v_mfma_f32_16x16x32_bf16 v[8:11], v[108:111], v[56:59], v[8:11]
    v_mul_f32 v30, s92, v30
    v_mul_f32 v31, s92, v31
    v_mfma_f32_16x16x32_bf16 v[12:15], v[124:127], v[56:59], v[12:15]
    v_cvt_pk_bf16_f32 v78, v28, v29
    v_cvt_pk_bf16_f32 v79, v30, v31
    buffer_store_dwordx4 v[76:79], v6, s[32:35], s60 offen sc1
    s_add_u32 s60, s60, 8192
    s_mov_b32 s58, 0
L_spin_10:
    ds_read_b32 v43, v42 offset:48
    s_add_u32 s58, s58, 1
    s_waitcnt lgkmcnt(0)
    v_readfirstlane_b32 s56, v43
    s_cmp_ge_u32 s56, 8
    s_cbranch_scc1 L_wbok
    s_sleep 1
    s_cmp_lt_u32 s58, 1048576
    s_cbranch_scc1 L_spin_10
L_wbok:
    ds_read_b64_tr_b16 v[96:97], v2 offset:8192
    ds_read_b64_tr_b16 v[98:99], v2 offset:8448
    ds_read_b64_tr_b16 v[112:113], v3 offset:8192
    ds_read_b64_tr_b16 v[114:115], v3 offset:8448
    ds_read_b64_tr_b16 v[100:101], v2 offset:10240
    ds_read_b64_tr_b16 v[102:103], v2 offset:10496
    ds_read_b64_tr_b16 v[116:117], v3 offset:10240
    ds_read_b64_tr_b16 v[118:119], v3 offset:10496
    ds_read_b64_tr_b16 v[104:105], v2 offset:12288
    ds_read_b64_tr_b16 v[106:107], v2 offset:12544
    ds_read_b64_tr_b16 v[120:121], v3 offset:12288
    ds_read_b64_tr_b16 v[122:123], v3 offset:12544
    ds_read_b64_tr_b16 v[108:109], v20 offset:0
    ds_read_b64_tr_b16 v[110:111], v20 offset:256
    ds_read_b64_tr_b16 v[124:125], v21 offset:0
    ds_read_b64_tr_b16 v[126:127], v21 offset:256
    ds_read_b128 v[44:47], v16 offset:0
    ds_read_b128 v[48:51], v17 offset:0
    ds_read_b128 v[52:55], v18 offset:0
    ds_read_b128 v[56:59], v19 offset:0
    v_mul_f32 v8, s92, v8
    v_mul_f32 v9, s92, v9
    v_mul_f32 v10, s92, v10
    v_mul_f32 v11, s92, v11
    v_cvt_pk_bf16_f32 v84, v8, v9
    v_mul_f32 v12, s92, v12
    v_mul_f32 v13, s92, v13
    v_cvt_pk_bf16_f32 v85, v10, v11
    v_mul_f32 v14, s92, v14
    v_mul_f32 v15, s92, v15
    v_cvt_pk_bf16_f32 v86, v12, v13
    v_cvt_pk_bf16_f32 v87, v14, v15
    buffer_store_dwordx4 v[84:87], v6, s[32:35], s60 offen sc1
    s_add_u32 s60, s60, 8192
L_stub3:
    s_cbranch_execz L_stub4
    s_setprio 0
    s_waitcnt lgkmcnt(0)
    v_mfma_f32_16x16x32_bf16 v[8:11], v[96:99], v[44:47], 0
    ds_read_b128 v[68:71], v16 offset:4096
    ds_read_b128 v[80:83], v17 offset:4096
    v_mfma_f32_16x16x32_bf16 v[12:15], v[112:115], v[44:47], 0
    ds_read_b128 v[88:91], v18 offset:4096
    ds_read_b128 v[92:95], v19 offset:4096
    v_mfma_f32_16x16x32_bf16 v[8:11], v[100:103], v[48:51], v[8:11]
    v_mfma_f32_16x16x32_bf16 v[12:15], v[116:119], v[48:51], v[12:15]
    v_mfma_f32_16x16x32_bf16 v[8:11], v[104:107], v[52:55], v[8:11]
    v_mfma_f32_16x16x32_bf16 v[12:15], v[120:123], v[52:55], v[12:15]
    v_mfma_f32_16x16x32_bf16 v[8:11], v[108:111], v[56:59], v[8:11]
    v_mfma_f32_16x16x32_bf16 v[12:15], v[124:127], v[56:59], v[12:15]
    s_waitcnt lgkmcnt(0)
    v_mfma_f32_16x16x32_bf16 v[24:27], v[96:99], v[68:71], 0
    ds_read_b128 v[44:47], v16 offset:8192
    ds_read_b128 v[48:51], v17 offset:8192
    v_mfma_f32_16x16x32_bf16 v[28:31], v[112:115], v[68:71], 0
    ds_read_b128 v[52:55], v18 offset:8192
    ds_read_b128 v[56:59], v19 offset:8192
    v_mfma_f32_16x16x32_bf16 v[24:27], v[100:103], v[80:83], v[24:27]
    ds_write_b128 v7, v[8:11] offset:0
    ds_write_b128 v7, v[12:15] offset:16
    v_mfma_f32_16x16x32_bf16 v[28:31], v[116:119], v[80:83], v[28:31]
    v_mfma_f32_16x16x32_bf16 v[24:27], v[104:107], v[88:91], v[24:27]
    v_mfma_f32_16x16x32_bf16 v[28:31], v[120:123], v[88:91], v[28:31]
    v_mfma_f32_16x16x32_bf16 v[24:27], v[108:111], v[92:95], v[24:27]
    v_mfma_f32_16x16x32_bf16 v[28:31], v[124:127], v[92:95], v[28:31]
    s_waitcnt lgkmcnt(2)
    v_mfma_f32_16x16x32_bf16 v[8:11], v[96:99], v[44:47], 0
    ds_read_b128 v[68:71], v16 offset:12288
    ds_read_b128 v[80:83], v17 offset:12288
    v_mfma_f32_16x16x32_bf16 v[12:15], v[112:115], v[44:47], 0
    ds_read_b128 v[88:91], v18 offset:12288
    ds_read_b128 v[92:95], v19 offset:12288
    v_mfma_f32_16x16x32_bf16 v[8:11], v[100:103], v[48:51], v[8:11]
    ds_write_b128 v7, v[24:27] offset:2304
    ds_write_b128 v7, v[28:31] offset:2320
    v_mfma_f32_16x16x32_bf16 v[12:15], v[116:119], v[48:51], v[12:15]
    v_mfma_f32_16x16x32_bf16 v[8:11], v[104:107], v[52:55], v[8:11]
    v_mfma_f32_16x16x32_bf16 v[12:15], v[120:123], v[52:55], v[12:15]
    v_mfma_f32_16x16x32_bf16 v[8:11], v[108:111], v[56:59], v[8:11]
    v_mfma_f32_16x16x32_bf16 v[12:15], v[124:127], v[56:59], v[12:15]
    s_waitcnt lgkmcnt(2)
    v_mfma_f32_16x16x32_bf16 v[24:27], v[96:99], v[68:71], 0
    ds_read_b128 v[44:47], v16 offset:16384
    ds_read_b128 v[48:51], v17 offset:16384
    v_mfma_f32_16x16x32_bf16 v[28:31], v[112:115], v[68:71], 0
    ds_read_b128 v[52:55], v18 offset:16384
    ds_read_b128 v[56:59], v19 offset:16384
    v_mfma_f32_16x16x32_bf16 v[24:27], v[100:103], v[80:83], v[24:27]
    ds_write_b128 v7, v[8:11] offset:4608
    ds_write_b128 v7, v[12:15] offset:4624
    v_mfma_f32_16x16x32_bf16 v[28:31], v[116:119], v[80:83], v[28:31]
    v_mfma_f32_16x16x32_bf16 v[24:27], v[104:107], v[88:91], v[24:27]
    v_mfma_f32_16x16x32_bf16 v[28:31], v[120:123], v[88:91], v[28:31]
    v_mfma_f32_16x16x32_bf16 v[24:27], v[108:111], v[92:95], v[24:27]
    v_mfma_f32_16x16x32_bf16 v[28:31], v[124:127], v[92:95], v[28:31]
    s_waitcnt lgkmcnt(2)
    v_mfma_f32_16x16x32_bf16 v[8:11], v[96:99], v[44:47], 0
    ds_read_b128 v[68:71], v16 offset:20480
    ds_read_b128 v[80:83], v17 offset:20480
    v_mfma_f32_16x16x32_bf16 v[12:15], v[112:115], v[44:47], 0
    ds_read_b128 v[88:91], v18 offset:20480
    ds_read_b128 v[92:95], v19 offset:20480
    v_mfma_f32_16x16x32_bf16 v[8:11], v[100:103], v[48:51], v[8:11]
    ds_write_b128 v7, v[24:27] offset:6912
    ds_write_b128 v7, v[28:31] offset:6928
    v_mfma_f32_16x16x32_bf16 v[12:15], v[116:119], v[48:51], v[12:15]
    v_mfma_f32_16x16x32_bf16 v[8:11], v[104:107], v[52:55], v[8:11]
    v_mfma_f32_16x16x32_bf16 v[12:15], v[120:123], v[52:55], v[12:15]
    v_mfma_f32_16x16x32_bf16 v[8:11], v[108:111], v[56:59], v[8:11]
    v_mfma_f32_16x16x32_bf16 v[12:15], v[124:127], v[56:59], v[12:15]
    s_cmp_lg_u32 s54, 0
    s_cbranch_scc1 L_nopub
    s_mov_b64 exec, 1
    v_mov_b32 v4, 1
    s_waitcnt vmcnt(0)
    ds_add_rtn_u32 v5, v42, v4 offset:4
    s_waitcnt lgkmcnt(0)
    v_readfirstlane_b32 s57, v5
    s_cmp_lg_u32 s57, 7
    s_cbranch_scc1 L_nopub
    s_mov_b64 exec, 0xff
    v_lshlrev_b32 v5, 10, v0
    v_mov_b32 v4, 1
    s_lshl_b32 s56, s2, 4
    s_and_b32 s56, s56, 0x380
    s_add_u32 s56, s56, 266870784
    buffer_atomic_add v4, v5, s[44:47], s56 offen sc1
    s_mov_b64 exec, 1
    global_atomic_add v42, v4, s[0:1] sc1
L_nopub:
    s_mov_b64 exec, -1
    s_waitcnt lgkmcnt(2)
    v_mfma_f32_16x16x32_bf16 v[24:27], v[96:99], v[68:71], 0
    ds_read_b128 v[44:47], v16 offset:24576
    ds_read_b128 v[48:51], v17 offset:24576
    v_mfma_f32_16x16x32_bf16 v[28:31], v[112:115], v[68:71], 0
    ds_read_b128 v[52:55], v18 offset:24576
    ds_read_b128 v[56:59], v19 offset:24576
    v_mfma_f32_16x16x32_bf16 v[24:27], v[100:103], v[80:83], v[24:27]
    ds_write_b128 v7, v[8:11] offset:9216
    ds_write_b128 v7, v[12:15] offset:9232
    v_mfma_f32_16x16x32_bf16 v[28:31], v[116:119], v[80:83], v[28:31]
    v_mfma_f32_16x16x32_bf16 v[24:27], v[104:107], v[88:91], v[24:27]
    v_mfma_f32_16x16x32_bf16 v[28:31], v[120:123], v[88:91], v[28:31]
    v_mfma_f32_16x16x32_bf16 v[24:27], v[108:111], v[92:95], v[24:27]
    v_mfma_f32_16x16x32_bf16 v[28:31], v[124:127], v[92:95], v[28:31]
    s_waitcnt lgkmcnt(2)
    v_mfma_f32_16x16x32_bf16 v[8:11], v[96:99], v[44:47], 0
    v_mfma_f32_16x16x32_bf16 v[12:15], v[112:115], v[44:47], 0
    v_mfma_f32_16x16x32_bf16 v[8:11], v[100:103], v[48:51], v[8:11]
    s_nop 2
    ds_write_b128 v7, v[24:27] offset:11520
    ds_write_b128 v7, v[28:31] offset:11536
    v_mfma_f32_16x16x32_bf16 v[12:15], v[116:119], v[48:51], v[12:15]
    v_mfma_f32_16x16x32_bf16 v[8:11], v[104:107], v[52:55], v[8:11]
    v_mfma_f32_16x16x32_bf16 v[12:15], v[120:123], v[52:55], v[12:15]
    v_mfma_f32_16x16x32_bf16 v[8:11], v[108:111], v[56:59], v[8:11]
    v_mfma_f32_16x16x32_bf16 v[12:15], v[124:127], v[56:59], v[12:15]
    s_mov_b32 exec_lo, 0x00030003
    s_mov_b32 exec_hi, 0x00030003
    s_nop 4
    ds_write_b128 v7, v[8:11] offset:13824
    ds_write_b128 v7, v[12:15] offset:13840
    s_mov_b64 exec, -1
    s_setprio 0
L_stub4:
    s_cbranch_execz L_W15cont
    s_mov_b32 s22, 0
    s_cmp_eq_u32 s3, 0
    s_cselect_b32 s22, 0x302e221c, s22
    s_cmp_eq_u32 s3, 1
    s_cselect_b32 s22, 0x2d1d01, s22
    s_cmp_eq_u32 s3, 2
    s_cselect_b32 s22, 0x25130a, s22
    s_cmp_eq_u32 s3, 3
    s_cselect_b32 s22, 0x2a1803, s22
    s_cmp_eq_u32 s3, 4
    s_cselect_b32 s22, 0x2f2700, s22
    s_cmp_eq_u32 s3, 5
    s_cselect_b32 s22, 0x201909, s22
    s_cmp_eq_u32 s3, 6
    s_cselect_b32 s22, 0x2c1702, s22
    s_cmp_eq_u32 s3, 7
    s_cselect_b32 s22, 0x2b1404, s22
    s_cmp_eq_u32 s3, 8
    s_cselect_b32 s22, 0x1e1a08, s22
    s_cmp_eq_u32 s3, 9
    s_cselect_b32 s22, 0x281506, s22
    s_cmp_eq_u32 s3, 10
    s_cselect_b32 s22, 0x211f05, s22
    s_cmp_eq_u32 s3, 11
    s_cselect_b32 s22, 0x26120b, s22
    s_cmp_eq_u32 s3, 12
    s_cselect_b32 s22, 0x240f0c, s22
    s_cmp_eq_u32 s3, 13
    s_cselect_b32 s22, 0x291007, s22
    s_cmp_eq_u32 s3, 14
    s_cselect_b32 s22, 0x23110d, s22
    s_cmp_eq_u32 s3, 15
    s_cselect_b32 s22, 0x1b160e, s22
    v_mul_u32_u24 v33, 43, v0
    v_lshrrev_b32 v33, 7, v33
    v_mul_u32_u24 v34, 24, v33
    v_lshlrev_b32 v32, 3, v0
    v_sub_u32 v32, v32, v34
    v_cmp_lt_u32 vcc, 14, v0
    s_nop 1
    v_cndmask_b32 v32, v32, 24, vcc
    v_bfe_u32 v32, s22, v32, 8
    v_lshlrev_b32 v32, 3, v32
    v_mad_u32_u24 v33, v33, 6, 8
    v_subrev_u32 v34, 6, v33
    v_min_u32 v33, 26, v33
    v_min_u32 v34, 26, v34
    s_mov_b32 s56, 48912210
    v_lshl_add_u32 v35, v0, 26, s56
    v_lshrrev_b32 v43, 5, v0
    s_bfe_u32 s56, s22, 0x80000
    s_bfe_u32 s57, s22, 0x80008
    s_bfe_u32 s58, s22, 0x80010
    s_lshl_b32 s56, s56, 3
    s_lshl_b32 s57, s57, 3
    s_lshl_b32 s58, s58, 3
    v_lshl_add_u32 v36, v43, 2, s56
    v_lshl_add_u32 v37, v43, 2, s57
    v_lshl_add_u32 v38, v43, 2, s58
    v_bfe_u32 v43, v0, 2, 3
    v_mul_u32_u24 v39, 14336, v43
    v_and_b32 v43, 3, v0
    v_lshl_add_u32 v39, v43, 5, v39
    v_and_b32 v43, 4, v0
    v_lshl_add_u32 v39, v43, 2, v39
    v_and_b32 v43, 8, v0
    v_lshl_add_u32 v39, v43, 4, v39
    v_add_u32 v39, 22384, v39
    s_lshl_b32 s56, s3, 6
    v_and_b32 v40, 60, v0
    v_add_u32 v40, s56, v40
    s_cmp_lg_u32 s54, 0
    s_cbranch_scc1 L_recovG
    v_and_b32 v9, 3, v0
    v_mul_u32_u24 v9, 112, v9
    v_mov_b32 v14, 0
    v_mov_b32 v15, 0
    s_waitcnt lgkmcnt(0)
    s_barrier
    ds_read_b32 v10, v40 offset:256
    ds_read_b128 v[96:99], v9 offset:256
    ds_read_b128 v[100:103], v9 offset:272
    ds_read_b128 v[104:107], v9 offset:288
    ds_read_b128 v[108:111], v9 offset:304
    ds_read_b128 v[112:115], v9 offset:320
    ds_read_b128 v[116:119], v9 offset:336
    ds_read_b128 v[120:123], v9 offset:352
    s_waitcnt lgkmcnt(6)
    v_cmp_gt_u32 s[96:97], v96, v10
    v_cmp_gt_u32 s[98:99], v97, v10
    v_cmp_gt_u32 s[56:57], v98, v10
    v_cmp_gt_u32 s[60:61], v99, v10
    v_addc_co_u32 v14, vcc, 0, v14, s[96:97]
    v_addc_co_u32 v15, vcc, 0, v15, s[98:99]
    v_addc_co_u32 v14, vcc, 0, v14, s[56:57]
    v_addc_co_u32 v15, vcc, 0, v15, s[60:61]
    s_waitcnt lgkmcnt(5)
    v_cmp_gt_u32 s[96:97], v100, v10
    v_cmp_gt_u32 s[98:99], v101, v10
    v_cmp_gt_u32 s[56:57], v102, v10
    v_cmp_gt_u32 s[60:61], v103, v10
    v_addc_co_u32 v14, vcc, 0, v14, s[96:97]
    v_addc_co_u32 v15, vcc, 0, v15, s[98:99]
    v_addc_co_u32 v14, vcc, 0, v14, s[56:57]
    v_addc_co_u32 v15, vcc, 0, v15, s[60:61]
    s_waitcnt lgkmcnt(4)
    v_cmp_gt_u32 s[96:97], v104, v10
    v_cmp_gt_u32 s[98:99], v105, v10
    v_cmp_gt_u32 s[56:57], v106, v10
    v_cmp_gt_u32 s[60:61], v107, v10
    v_addc_co_u32 v14, vcc, 0, v14, s[96:97]
    v_addc_co_u32 v15, vcc, 0, v15, s[98:99]
    v_addc_co_u32 v14, vcc, 0, v14, s[56:57]
    v_addc_co_u32 v15, vcc, 0, v15, s[60:61]
    s_waitcnt lgkmcnt(3)
    v_cmp_gt_u32 s[96:97], v108, v10
    v_cmp_gt_u32 s[98:99], v109, v10
    v_cmp_gt_u32 s[56:57], v110, v10
    v_cmp_gt_u32 s[60:61], v111, v10
    v_addc_co_u32 v14, vcc, 0, v14, s[96:97]
    v_addc_co_u32 v15, vcc, 0, v15, s[98:99]
    v_addc_co_u32 v14, vcc, 0, v14, s[56:57]
    v_addc_co_u32 v15, vcc, 0, v15, s[60:61]
    s_waitcnt lgkmcnt(2)
    v_cmp_gt_u32 s[96:97], v112, v10
    v_cmp_gt_u32 s[98:99], v113, v10
    v_cmp_gt_u32 s[56:57], v114, v10
    v_cmp_gt_u32 s[60:61], v115, v10
    v_addc_co_u32 v14, vcc, 0, v14, s[96:97]
    v_addc_co_u32 v15, vcc, 0, v15, s[98:99]
    v_addc_co_u32 v14, vcc, 0, v14, s[56:57]
    v_addc_co_u32 v15, vcc, 0, v15, s[60:61]
    s_waitcnt lgkmcnt(1)
    v_cmp_gt_u32 s[96:97], v116, v10
    v_cmp_gt_u32 s[98:99], v117, v10
    v_cmp_gt_u32 s[56:57], v118, v10
    v_cmp_gt_u32 s[60:61], v119, v10
    v_addc_co_u32 v14, vcc, 0, v14, s[96:97]
    v_addc_co_u32 v15, vcc, 0, v15, s[98:99]
    v_addc_co_u32 v14, vcc, 0, v14, s[56:57]
    v_addc_co_u32 v15, vcc, 0, v15, s[60:61]
    s_waitcnt lgkmcnt(0)
    v_cmp_gt_u32 s[96:97], v120, v10
    v_cmp_gt_u32 s[98:99], v121, v10
    v_cmp_gt_u32 s[56:57], v122, v10
    v_cmp_gt_u32 s[60:61], v123, v10
    v_addc_co_u32 v14, vcc, 0, v14, s[96:97]
    v_addc_co_u32 v15, vcc, 0, v15, s[98:99]
    v_addc_co_u32 v14, vcc, 0, v14, s[56:57]
    v_addc_co_u32 v15, vcc, 0, v15, s[60:61]
    v_add_u32 v15, v14, v15
    s_nop 1
    v_add_u32_dpp v15, v15, v15 quad_perm:[1,0,3,2] row_mask:0xf bank_mask:0xf
    s_nop 1
    v_add_u32_dpp v15, v15, v15 quad_perm:[2,3,0,1] row_mask:0xf bank_mask:0xf
    v_lshlrev_b32 v15, 2, v15
    ds_write_b32 v15, v10 offset:768
L_C2:
    s_waitcnt lgkmcnt(0)
    s_barrier
L_B4:
    ds_read_b64 v[4:5], v32 offset:768
    ds_read_b32 v43, v42 offset:12
    ds_read_b32 v36, v36 offset:768
    ds_read_b32 v37, v37 offset:768
    ds_read_b32 v38, v38 offset:768
    s_mul_i32 s59, s3, 1536
    s_add_u32 s59, s59, 136816
    v_lshl_add_u32 v6, v0, 2, s59
    v_mov_b32 v8, 0
    v_mov_b32 v40, 0
    ds_write2st64_b32 v6, v8, v8 offset0:0 offset1:1
L_stub5:
    s_cbranch_execz L_stub12
    s_mov_b32 s96, 0x47000
    s_mov_b32 s97, 0
    s_cmp_eq_u32 s3, 0
    s_movk_i32 s98, 0x7fff
    s_cselect_b32 s98, 0x4ffff, s98
    s_mov_b32 s99, 0
    s_movk_i32 s60, -46
    s_movk_i32 s61, 8193
    s_waitcnt lgkmcnt(4)
    v_cndmask_b32 v7, v5, v4, s[96:97]
    v_bfe_u32 v9, v4, v33, 6
    v_bfe_u32 v11, v4, v34, 6
    v_bfe_u32 v12, v5, v34, 6
    v_bfe_u32 v10, v7, v33, 6
    s_mov_b64 exec, 0x47ff8
    v_min_u32 v8, v11, v12
    s_mov_b64 exec, s[98:99]
    v_min_u32 v9, v9, v10
    v_sub_u32 v40, v9, v8
    s_mov_b64 exec, -1
    v_mov_b32 v10, v40
    v_and_b32 v11, 127, v4
    v_and_b32 v12, 127, v7
    v_add_u32_dpp v10, v10, v10 row_shr:1 row_mask:0xf bank_mask:0xf bound_ctrl:0
    v_lshl_add_u32 v11, v12, 13, v11
    v_readfirstlane_b32 s55, v43
    v_add_u32_dpp v10, v10, v10 row_shr:2 row_mask:0xf bank_mask:0xf bound_ctrl:0
    v_mad_i32_i24 v11, v11, s60, v35
    v_cmp_lt_u32 vcc, 0, v40
    v_add_u32_dpp v10, v10, v10 row_shr:4 row_mask:0xf bank_mask:0xf bound_ctrl:0
    v_lshl_add_u32 v13, v0, 3, s59
    v_lshrrev_b32 v1, 5, v0
    v_add_u32_dpp v10, v10, v10 row_shr:8 row_mask:0xf bank_mask:0xf bound_ctrl:0
    v_mul_u32_u24 v1, 768, v1
    v_add_u32 v1, s59, v1
    v_add_u32_dpp v10, v10, v10 row_bcast:15 row_mask:0xa bank_mask:0xf
    v_sub_u32 v12, v10, v40
    v_sub_u32 v9, v9, v10
    v_readlane_b32 s58, v10, 20
    v_lshl_add_u32 v12, v12, 2, s59
    v_mad_i32_i24 v11, v9, s61, v11
    s_sub_u32 s56, s58, 1
    s_cmp_lt_u32 s56, 92
    s_cbranch_scc1 L_capok
    s_or_b32 s55, s55, 4
L_capok:
    s_cmp_lg_u32 s3, 15
    s_cbranch_scc1 L_nopre2
    s_cmp_lg_u32 s54, 0
    s_cbranch_scc1 L_nopre2
    s_mov_b64 exec, 0xff00
    buffer_load_dword v54, v52, s[44:47], s23 offen sc1
    s_mov_b64 exec, -1
L_nopre2:
    s_cmp_lg_u32 s55, 0
    s_cbranch_scc1 L_nolist
    s_mov_b64 exec, vcc
    ds_write_b32 v12, v11
    s_mov_b64 exec, -1
    ds_read2st64_b32 v[10:11], v6 offset0:0 offset1:1
    v_min_u32 v9, s56, v0
    s_mov_b32 s57, 118272
    v_lshl_add_u32 v9, v9, 2, s57
    s_movk_i32 s60, 512
    s_waitcnt lgkmcnt(0)
    v_max_u32_dpp v10, v10, v10 row_shr:1 row_mask:0xf bank_mask:0xf bound_ctrl:0
    s_nop 1
    v_max_u32_dpp v10, v10, v10 row_shr:2 row_mask:0xf bank_mask:0xf bound_ctrl:0
    s_nop 1
    v_max_u32_dpp v10, v10, v10 row_shr:4 row_mask:0xf bank_mask:0xf bound_ctrl:0
    s_nop 1
    v_max_u32_dpp v10, v10, v10 row_shr:8 row_mask:0xf bank_mask:0xf bound_ctrl:0
    s_nop 1
    v_max_u32_dpp v10, v10, v10 row_bcast:15 row_mask:0xa bank_mask:0xf
    s_nop 1
    v_max_u32_dpp v10, v10, v10 row_bcast:31 row_mask:0xc bank_mask:0xf
    v_and_b32 v14, 0x1fff, v10
    v_bfe_u32 v15, v10, 13, 13
    v_lshl_add_u32 v14, v14, 2, v9
    v_lshl_add_u32 v15, v15, 2, v9
    ds_read_b32 v14, v14
    ds_read_b32 v15, v15
    s_waitcnt lgkmcnt(1)
    v_and_b32 v16, 0x7fff, v14
    v_mad_u32_u24 v16, v16, s60, s60
    v_and_b32 v14, s26, v14
    ds_write2_b32 v13, v16, v14 offset0:0 offset1:9
    s_waitcnt lgkmcnt(1)
    v_and_b32 v17, 0x7fff, v15
    v_lshlrev_b32 v17, 9, v17
    v_and_b32 v15, s26, v15
    ds_write2_b32 v13, v17, v15 offset0:192 offset1:201
    s_cmp_gt_u32 s58, 60
    s_cbranch_scc1 L_fill2
L_filled:
L_nolist:
    ds_read_b128 v[8:11], v1
    ds_read_b128 v[12:15], v1 offset:16
    ds_read_b128 v[16:19], v1 offset:32
    ds_read_b128 v[20:23], v1 offset:48
    s_movk_i32 s60, -144
    v_and_b32 v36, 127, v36
    v_and_b32 v37, 127, v37
    v_and_b32 v38, 127, v38
    v_mad_i32_i24 v36, v36, s60, v39
    v_mad_i32_i24 v37, v37, s60, v39
    v_mad_i32_i24 v38, v38, s60, v39
    s_bitcmp1_b32 s55, 1
    s_cbranch_scc1 L_recover
    s_cmp_lg_u32 s3, 15
    s_cbranch_scc1 L_pfdone
    s_cmp_lg_u32 s54, 0
    s_cbranch_scc1 L_pfdone
    s_mov_b32 s56, 0
    s_mov_b64 exec, 0xff00
    v_mov_b32 v55, 1
L_pfp:
    s_waitcnt vmcnt(0)
    v_cmp_ne_u32 vcc, v54, v53
    s_nop 0
    s_cbranch_vccz L_pfok
    s_mov_b64 exec, vcc
    s_cmp_lt_u32 s56, 16
    s_cbranch_scc1 L_dk_11
    global_load_dword v54, v42, s[0:1] sc1
    s_waitcnt vmcnt(0)
    v_readfirstlane_b32 s57, v54
    s_cmp_eq_u32 s57, s100
    s_cbranch_scc1 L_pfok
L_dk_11:
    s_sleep 1
    buffer_load_dword v54, v52, s[44:47], s23 offen sc1
    s_add_u32 s56, s56, 1
    s_cmp_lt_u32 s56, 6000
    s_cbranch_scc1 L_pfp
    v_mov_b32 v55, 2
L_pfok:
    ds_write_b32 v42, v55 offset:28
    s_mov_b64 exec, -1
L_pfdone:
    ds_read_b32 v43, v42 offset:28
    ds_read_b128 v[56:59], v36 offset:0
    ds_read_b128 v[68:71], v36 offset:16
    ds_read_b128 v[80:83], v37 offset:0
    ds_read_b128 v[92:95], v37 offset:16
    ds_read_b128 v[104:107], v38 offset:0
    ds_read_b128 v[116:119], v38 offset:16
    v_lshrrev_b32 v32, 26, v4
    v_lshrrev_b32 v33, 26, v5
    v_and_b32 v4, 127, v4
    v_and_b32 v5, 127, v5
    v_lshl_or_b32 v32, v32, 8, v4
    v_lshl_or_b32 v33, v33, 8, v5
    s_mul_i32 s80, s3, 6
    s_min_u32 s56, s3, 1
    s_lshl1_add_u32 s80, s56, s80
    s_lshl_b32 s56, s80, 2
    v_min_u32 v34, 3, v0
    v_lshl_add_u32 v34, v34, 3, s56
    s_and_b32 s98, s98, 0x8007
    s_waitcnt lgkmcnt(6)
    v_readfirstlane_b32 s82, v43
    s_cmp_lg_u32 s55, 0
    s_cselect_b32 s82, 0, s82
    s_cmp_lg_u32 s82, 1
    s_cbranch_scc1 L_noring
    buffer_load_dwordx4 v[24:27], v8, s[40:43], s70 offen sc1
    buffer_load_dwordx4 v[28:31], v10, s[40:43], s70 offen sc1
    buffer_load_dwordx4 v[44:47], v12, s[40:43], s70 offen sc1
    buffer_load_dwordx4 v[48:51], v14, s[40:43], s70 offen sc1
L_noring:
    s_mov_b64 exec, s[98:99]
    ds_write_b64 v34, v[32:33] offset:1280
    s_mov_b64 exec, -1
    v_and_b32 v34, 31, v0
    v_lshlrev_b32 v34, 5, v34
    s_cmp_lg_u32 s3, 0
    s_cbranch_scc1 L_noq3
    v_readlane_b32 s56, v4, 15
    v_readlane_b32 s57, v5, 15
    s_nop 0
    v_mov_b32 v35, s56
    s_mov_b32 exec_lo, 0
    v_mov_b32 v35, s57
    s_mov_b32 exec_lo, -1
    v_mad_i32_i24 v35, v35, s60, v39
    ds_read_b128 v[108:111], v35
    ds_read_b128 v[112:115], v35 offset:16
L_noq3:
L_stub6:
    s_cbranch_execz L_stub13
    ds_read_b128 v[120:123], v34 offset:3072
    ds_read_b128 v[124:127], v34 offset:3088
    ds_read_b128 v[4:7], v34 offset:2048
    ds_read_b128 v[52:55], v34 offset:2064
    v_and_b32 v35, 3, v0
    v_lshlrev_b32 v35, 4, v35
    v_mov_b32 v36, 0x3f80
    v_mov_b32 v37, 0
    v_lshlrev_b64 v[2:3], v35, v[36:37]
    v_mov_b32 v43, 1
    s_mov_b32 s60, 1.0
    s_mov_b32 s61, 1.0
    s_mov_b32 s56, 0xbfb8aa3b
    s_mov_b32 s57, 0xbfb8aa3b
    s_mov_b32 s71, 0
    s_mov_b32 s83, 0
    s_mov_b32 s28, s16
    s_mov_b32 s29, s17
    s_mov_b32 s30, 65536
    s_mov_b32 s31, 0x00020000
    v_mov_b64 v[60:61], 0
    v_mov_b64 v[62:63], 0
    v_mov_b64 v[64:65], s[60:61]
    v_mov_b64 v[66:67], s[60:61]
    v_mov_b64 v[72:73], 0
    v_mov_b64 v[74:75], 0
    v_mov_b64 v[76:77], s[60:61]
    v_mov_b64 v[78:79], s[60:61]
    v_mov_b64 v[84:85], 0
    v_mov_b64 v[86:87], 0
    v_mov_b64 v[88:89], s[60:61]
    v_mov_b64 v[90:91], s[60:61]
    v_mov_b64 v[96:97], 0
    v_mov_b64 v[98:99], 0
    v_mov_b64 v[100:101], s[60:61]
    v_mov_b64 v[102:103], s[60:61]
    s_waitcnt lgkmcnt(2)
    s_mov_b64 exec, 1
    ds_add_u32 v42, v43 offset:20
    s_mov_b64 exec, -1
    v_pk_fma_f32 v[56:57], v[56:57], s[56:57], v[120:121]
    v_pk_fma_f32 v[58:59], v[58:59], s[56:57], v[122:123]
    v_pk_fma_f32 v[68:69], v[68:69], s[56:57], v[124:125]
    v_pk_fma_f32 v[70:71], v[70:71], s[56:57], v[126:127]
    v_pk_fma_f32 v[80:81], v[80:81], s[56:57], v[120:121]
    v_pk_fma_f32 v[82:83], v[82:83], s[56:57], v[122:123]
    v_pk_fma_f32 v[92:93], v[92:93], s[56:57], v[124:125]
    v_pk_fma_f32 v[94:95], v[94:95], s[56:57], v[126:127]
    v_pk_fma_f32 v[104:105], v[104:105], s[56:57], v[120:121]
    v_pk_fma_f32 v[106:107], v[106:107], s[56:57], v[122:123]
    v_pk_fma_f32 v[116:117], v[116:117], s[56:57], v[124:125]
    v_pk_fma_f32 v[118:119], v[118:119], s[56:57], v[126:127]
    s_cmp_lg_u32 s3, 0
    s_cbranch_scc1 L_noq3b
    s_mov_b32 s58, 161792
    v_lshl_add_u32 v35, v0, 4, s58
    v_pk_fma_f32 v[108:109], v[108:109], s[56:57], v[120:121]
    v_pk_fma_f32 v[110:111], v[110:111], s[56:57], v[122:123]
    v_pk_fma_f32 v[112:113], v[112:113], s[56:57], v[124:125]
    v_pk_fma_f32 v[114:115], v[114:115], s[56:57], v[126:127]
    ds_write_b128 v35, v[108:111]
    ds_write_b128 v35, v[112:115] offset:1024
    s_waitcnt lgkmcnt(0)
L_noq3b:
    v_mov_b64 v[108:109], 0
    v_mov_b64 v[110:111], 0
    v_mov_b64 v[112:113], s[60:61]
    v_mov_b64 v[114:115], s[60:61]
    v_mov_b64 v[120:121], 0
    v_mov_b64 v[122:123], 0
    v_mov_b64 v[124:125], s[60:61]
    v_mov_b64 v[126:127], s[60:61]
    s_cmp_eq_u32 s82, 1
    s_cbranch_scc1 L_ringd
    s_mov_b32 s56, 0
L_spin_12:
    ds_read_b32 v43, v42 offset:28
    s_add_u32 s56, s56, 1
    s_waitcnt lgkmcnt(0)
    v_readfirstlane_b32 s57, v43
    s_cmp_lg_u32 s57, 0
    s_cbranch_scc1 L_pfseen
    s_sleep 1
    s_cmp_lt_u32 s56, 1048576
    s_cbranch_scc1 L_spin_12
L_pfseen:
    s_cmp_lg_u32 s57, 1
    s_cbranch_scc1 L_recover
    s_cmp_lg_u32 s55, 0
    s_cbranch_scc1 L_safe0
    buffer_load_dwordx4 v[24:27], v8, s[40:43], s70 offen sc1
    buffer_load_dwordx4 v[28:31], v10, s[40:43], s70 offen sc1
    buffer_load_dwordx4 v[44:47], v12, s[40:43], s70 offen sc1
    buffer_load_dwordx4 v[48:51], v14, s[40:43], s70 offen sc1
L_ringd:
    s_waitcnt lgkmcnt(0)
    s_setprio 3
L_E0_0:
    v_readlane_b32 s56, v40, s71
    s_add_u32 s71, s71, 1
    s_sub_u32 s56, s56, 1
    s_cbranch_scc1 L_E1_0
    s_waitcnt lgkmcnt(1)
    v_pk_fma_f32 v[8:9], v[16:17], v[4:5], v[56:57] op_sel:[1,0,0] op_sel_hi:[1,1,1]
    v_pk_fma_f32 v[10:11], v[16:17], v[6:7], v[58:59] op_sel:[1,0,0] op_sel_hi:[1,1,1]
    v_pk_fma_f32 v[32:33], v[16:17], v[52:53], v[68:69] op_sel:[1,0,0] op_sel_hi:[1,1,1]
    v_pk_fma_f32 v[34:35], v[16:17], v[54:55], v[70:71] op_sel:[1,0,0] op_sel_hi:[1,1,1]
    s_waitcnt vmcnt(3)
    s_sub_u32 s56, s56, 1
    v_mfma_f32_4x4x4_16b_bf16 v[8:11], v[2:3], v[24:25], v[8:11]
    v_mfma_f32_4x4x4_16b_bf16 v[32:35], v[2:3], v[26:27], v[32:35]
    buffer_load_dwordx4 v[24:27], v16, s[40:43], s70 offen sc1
    s_nop 2
    v_exp_f32 v12, v8
    v_exp_f32 v13, v9
    v_exp_f32 v14, v10
    v_exp_f32 v15, v11
    v_pk_fma_f32 v[8:9], v[8:9], v[64:65], v[60:61]
    v_pk_fma_f32 v[10:11], v[10:11], v[66:67], v[62:63]
    v_pk_fma_f32 v[64:65], v[64:65], v[12:13], v[64:65]
    v_pk_fma_f32 v[60:61], v[60:61], v[12:13], v[8:9]
    v_pk_fma_f32 v[66:67], v[66:67], v[14:15], v[66:67]
    v_pk_fma_f32 v[62:63], v[62:63], v[14:15], v[10:11]
    s_cbranch_scc0 L_B0_1
    s_branch L_T0_1
L_T0_0:
    v_exp_f32 v12, v32
    v_exp_f32 v13, v33
    v_exp_f32 v14, v34
    v_exp_f32 v15, v35
    v_pk_fma_f32 v[32:33], v[32:33], v[76:77], v[72:73]
    v_pk_fma_f32 v[34:35], v[34:35], v[78:79], v[74:75]
    v_pk_fma_f32 v[76:77], v[76:77], v[12:13], v[76:77]
    v_pk_fma_f32 v[72:73], v[72:73], v[12:13], v[32:33]
    v_pk_fma_f32 v[78:79], v[78:79], v[14:15], v[78:79]
    v_pk_fma_f32 v[74:75], v[74:75], v[14:15], v[34:35]
L_E1_0:
    s_mov_b32 s57, 0
    s_cmp_eq_u32 s71, 4
    s_cbranch_scc1 L_hk1
L_H_0:
    v_readlane_b32 s56, v40, s71
    s_add_u32 s71, s71, 1
    s_sub_u32 s56, s56, 1
    s_cbranch_scc1 L_E2_0
    s_waitcnt lgkmcnt(1)
    v_pk_fma_f32 v[8:9], v[16:17], v[4:5], v[80:81] op_sel:[1,0,0] op_sel_hi:[1,1,1]
    v_pk_fma_f32 v[10:11], v[16:17], v[6:7], v[82:83] op_sel:[1,0,0] op_sel_hi:[1,1,1]
    v_pk_fma_f32 v[32:33], v[16:17], v[52:53], v[92:93] op_sel:[1,0,0] op_sel_hi:[1,1,1]
    v_pk_fma_f32 v[34:35], v[16:17], v[54:55], v[94:95] op_sel:[1,0,0] op_sel_hi:[1,1,1]
    s_waitcnt vmcnt(3)
    s_sub_u32 s56, s56, 1
    v_mfma_f32_4x4x4_16b_bf16 v[8:11], v[2:3], v[24:25], v[8:11]
    v_mfma_f32_4x4x4_16b_bf16 v[32:35], v[2:3], v[26:27], v[32:35]
    buffer_load_dwordx4 v[24:27], v16, s[40:43], s70 offen sc1
    s_nop 2
    v_exp_f32 v12, v8
    v_exp_f32 v13, v9
    v_exp_f32 v14, v10
    v_exp_f32 v15, v11
    v_pk_fma_f32 v[8:9], v[8:9], v[88:89], v[84:85]
    v_pk_fma_f32 v[10:11], v[10:11], v[90:91], v[86:87]
    v_pk_fma_f32 v[88:89], v[88:89], v[12:13], v[88:89]
    v_pk_fma_f32 v[84:85], v[84:85], v[12:13], v[8:9]
    v_pk_fma_f32 v[90:91], v[90:91], v[14:15], v[90:91]
    v_pk_fma_f32 v[86:87], v[86:87], v[14:15], v[10:11]
    s_cbranch_scc0 L_B1_1
    s_branch L_T1_1
L_T1_0:
    v_exp_f32 v12, v32
    v_exp_f32 v13, v33
    v_exp_f32 v14, v34
    v_exp_f32 v15, v35
    v_pk_fma_f32 v[32:33], v[32:33], v[100:101], v[96:97]
    v_pk_fma_f32 v[34:35], v[34:35], v[102:103], v[98:99]
    v_pk_fma_f32 v[100:101], v[100:101], v[12:13], v[100:101]
    v_pk_fma_f32 v[96:97], v[96:97], v[12:13], v[32:33]
    v_pk_fma_f32 v[102:103], v[102:103], v[14:15], v[102:103]
    v_pk_fma_f32 v[98:99], v[98:99], v[14:15], v[34:35]
L_E2_0:
    v_readlane_b32 s56, v40, s71
    s_add_u32 s71, s71, 1
    s_sub_u32 s56, s56, 1
    s_cbranch_scc1 L_E3_0
    s_waitcnt lgkmcnt(1)
    v_pk_fma_f32 v[8:9], v[16:17], v[4:5], v[104:105] op_sel:[1,0,0] op_sel_hi:[1,1,1]
    v_pk_fma_f32 v[10:11], v[16:17], v[6:7], v[106:107] op_sel:[1,0,0] op_sel_hi:[1,1,1]
    v_pk_fma_f32 v[32:33], v[16:17], v[52:53], v[116:117] op_sel:[1,0,0] op_sel_hi:[1,1,1]
    v_pk_fma_f32 v[34:35], v[16:17], v[54:55], v[118:119] op_sel:[1,0,0] op_sel_hi:[1,1,1]
    s_waitcnt vmcnt(3)
    s_sub_u32 s56, s56, 1
    v_mfma_f32_4x4x4_16b_bf16 v[8:11], v[2:3], v[24:25], v[8:11]
    v_mfma_f32_4x4x4_16b_bf16 v[32:35], v[2:3], v[26:27], v[32:35]
    buffer_load_dwordx4 v[24:27], v16, s[40:43], s70 offen sc1
    s_nop 2
    v_exp_f32 v12, v8
    v_exp_f32 v13, v9
    v_exp_f32 v14, v10
    v_exp_f32 v15, v11
    v_pk_fma_f32 v[8:9], v[8:9], v[112:113], v[108:109]
    v_pk_fma_f32 v[10:11], v[10:11], v[114:115], v[110:111]
    v_pk_fma_f32 v[112:113], v[112:113], v[12:13], v[112:113]
    v_pk_fma_f32 v[108:109], v[108:109], v[12:13], v[8:9]
    v_pk_fma_f32 v[114:115], v[114:115], v[14:15], v[114:115]
    v_pk_fma_f32 v[110:111], v[110:111], v[14:15], v[10:11]
    s_cbranch_scc0 L_B2_1
    s_branch L_T2_1
L_stub7:
    s_branch L_stub14
L_T2_0:
    v_exp_f32 v12, v32
    v_exp_f32 v13, v33
    v_exp_f32 v14, v34
    v_exp_f32 v15, v35
    v_pk_fma_f32 v[32:33], v[32:33], v[124:125], v[120:121]
    v_pk_fma_f32 v[34:35], v[34:35], v[126:127], v[122:123]
    v_pk_fma_f32 v[124:125], v[124:125], v[12:13], v[124:125]
    v_pk_fma_f32 v[120:121], v[120:121], v[12:13], v[32:33]
    v_pk_fma_f32 v[126:127], v[126:127], v[14:15], v[126:127]
    v_pk_fma_f32 v[122:123], v[122:123], v[14:15], v[34:35]
L_E3_0:
    s_mov_b32 s57, 0
    s_cmp_eq_u32 s71, 3
    s_cbranch_scc1 L_wrap1
    s_setprio 1
    s_cmp_eq_u32 s71, 6
    s_cbranch_scc1 L_E0_0
    s_setprio 0
    s_cmp_eq_u32 s71, 9
    s_cbranch_scc1 L_E0_0
    s_mov_b32 exec_hi, 0
    s_cmp_eq_u32 s71, 12
    s_cbranch_scc1 L_E0_0
    s_cmp_eq_u32 s71, 18
    s_cbranch_scc1 L_E0_0
    s_mov_b32 exec_hi, -1
    s_cmp_lg_u32 s3, s83
    s_cbranch_scc1 L_flush
    s_branch L_rs0
L_E0_1:
    v_readlane_b32 s56, v40, s71
    s_add_u32 s71, s71, 1
    s_sub_u32 s56, s56, 1
    s_cbranch_scc1 L_E1_1
    v_pk_fma_f32 v[8:9], v[18:19], v[4:5], v[56:57] op_sel:[1,0,0] op_sel_hi:[1,1,1]
    v_pk_fma_f32 v[10:11], v[18:19], v[6:7], v[58:59] op_sel:[1,0,0] op_sel_hi:[1,1,1]
    v_pk_fma_f32 v[32:33], v[18:19], v[52:53], v[68:69] op_sel:[1,0,0] op_sel_hi:[1,1,1]
    v_pk_fma_f32 v[34:35], v[18:19], v[54:55], v[70:71] op_sel:[1,0,0] op_sel_hi:[1,1,1]
    s_waitcnt vmcnt(3)
    s_sub_u32 s56, s56, 1
    v_mfma_f32_4x4x4_16b_bf16 v[8:11], v[2:3], v[28:29], v[8:11]
    v_mfma_f32_4x4x4_16b_bf16 v[32:35], v[2:3], v[30:31], v[32:35]
    buffer_load_dwordx4 v[28:31], v18, s[40:43], s70 offen sc1
    ds_read_b128 v[16:19], v1 offset:64
    s_nop 1
    v_exp_f32 v12, v8
    v_exp_f32 v13, v9
    v_exp_f32 v14, v10
    v_exp_f32 v15, v11
    v_pk_fma_f32 v[8:9], v[8:9], v[64:65], v[60:61]
    v_pk_fma_f32 v[10:11], v[10:11], v[66:67], v[62:63]
    v_pk_fma_f32 v[64:65], v[64:65], v[12:13], v[64:65]
    v_pk_fma_f32 v[60:61], v[60:61], v[12:13], v[8:9]
    v_pk_fma_f32 v[66:67], v[66:67], v[14:15], v[66:67]
    v_pk_fma_f32 v[62:63], v[62:63], v[14:15], v[10:11]
    s_cbranch_scc0 L_B0_2
    s_branch L_T0_2
L_T0_1:
    v_exp_f32 v12, v32
    v_exp_f32 v13, v33
    v_exp_f32 v14, v34
    v_exp_f32 v15, v35
    v_pk_fma_f32 v[32:33], v[32:33], v[76:77], v[72:73]
    v_pk_fma_f32 v[34:35], v[34:35], v[78:79], v[74:75]
    v_pk_fma_f32 v[76:77], v[76:77], v[12:13], v[76:77]
    v_pk_fma_f32 v[72:73], v[72:73], v[12:13], v[32:33]
    v_pk_fma_f32 v[78:79], v[78:79], v[14:15], v[78:79]
    v_pk_fma_f32 v[74:75], v[74:75], v[14:15], v[34:35]
L_E1_1:
    s_mov_b32 s57, 1
    s_cmp_eq_u32 s71, 4
    s_cbranch_scc1 L_hk1
L_H_1:
    v_readlane_b32 s56, v40, s71
    s_add_u32 s71, s71, 1
    s_sub_u32 s56, s56, 1
    s_cbranch_scc1 L_E2_1
    v_pk_fma_f32 v[8:9], v[18:19], v[4:5], v[80:81] op_sel:[1,0,0] op_sel_hi:[1,1,1]
    v_pk_fma_f32 v[10:11], v[18:19], v[6:7], v[82:83] op_sel:[1,0,0] op_sel_hi:[1,1,1]
    v_pk_fma_f32 v[32:33], v[18:19], v[52:53], v[92:93] op_sel:[1,0,0] op_sel_hi:[1,1,1]
    v_pk_fma_f32 v[34:35], v[18:19], v[54:55], v[94:95] op_sel:[1,0,0] op_sel_hi:[1,1,1]
    s_waitcnt vmcnt(3)
    s_sub_u32 s56, s56, 1
    v_mfma_f32_4x4x4_16b_bf16 v[8:11], v[2:3], v[28:29], v[8:11]
    v_mfma_f32_4x4x4_16b_bf16 v[32:35], v[2:3], v[30:31], v[32:35]
    buffer_load_dwordx4 v[28:31], v18, s[40:43], s70 offen sc1
    ds_read_b128 v[16:19], v1 offset:64
    s_nop 1
    v_exp_f32 v12, v8
    v_exp_f32 v13, v9
    v_exp_f32 v14, v10
    v_exp_f32 v15, v11
    v_pk_fma_f32 v[8:9], v[8:9], v[88:89], v[84:85]
    v_pk_fma_f32 v[10:11], v[10:11], v[90:91], v[86:87]
    v_pk_fma_f32 v[88:89], v[88:89], v[12:13], v[88:89]
    v_pk_fma_f32 v[84:85], v[84:85], v[12:13], v[8:9]
    v_pk_fma_f32 v[90:91], v[90:91], v[14:15], v[90:91]
    v_pk_fma_f32 v[86:87], v[86:87], v[14:15], v[10:11]
    s_cbranch_scc0 L_B1_2
    s_branch L_T1_2
L_T1_1:
    v_exp_f32 v12, v32
    v_exp_f32 v13, v33
    v_exp_f32 v14, v34
    v_exp_f32 v15, v35
    v_pk_fma_f32 v[32:33], v[32:33], v[100:101], v[96:97]
    v_pk_fma_f32 v[34:35], v[34:35], v[102:103], v[98:99]
    v_pk_fma_f32 v[100:101], v[100:101], v[12:13], v[100:101]
    v_pk_fma_f32 v[96:97], v[96:97], v[12:13], v[32:33]
    v_pk_fma_f32 v[102:103], v[102:103], v[14:15], v[102:103]
    v_pk_fma_f32 v[98:99], v[98:99], v[14:15], v[34:35]
L_E2_1:
    v_readlane_b32 s56, v40, s71
    s_add_u32 s71, s71, 1
    s_sub_u32 s56, s56, 1
    s_cbranch_scc1 L_E3_1
    v_pk_fma_f32 v[8:9], v[18:19], v[4:5], v[104:105] op_sel:[1,0,0] op_sel_hi:[1,1,1]
    v_pk_fma_f32 v[10:11], v[18:19], v[6:7], v[106:107] op_sel:[1,0,0] op_sel_hi:[1,1,1]
    v_pk_fma_f32 v[32:33], v[18:19], v[52:53], v[116:117] op_sel:[1,0,0] op_sel_hi:[1,1,1]
    v_pk_fma_f32 v[34:35], v[18:19], v[54:55], v[118:119] op_sel:[1,0,0] op_sel_hi:[1,1,1]
    s_waitcnt vmcnt(3)
    s_sub_u32 s56, s56, 1
    v_mfma_f32_4x4x4_16b_bf16 v[8:11], v[2:3], v[28:29], v[8:11]
    v_mfma_f32_4x4x4_16b_bf16 v[32:35], v[2:3], v[30:31], v[32:35]
    buffer_load_dwordx4 v[28:31], v18, s[40:43], s70 offen sc1
    ds_read_b128 v[16:19], v1 offset:64
    s_nop 1
    v_exp_f32 v12, v8
    v_exp_f32 v13, v9
    v_exp_f32 v14, v10
    v_exp_f32 v15, v11
    v_pk_fma_f32 v[8:9], v[8:9], v[112:113], v[108:109]
    v_pk_fma_f32 v[10:11], v[10:11], v[114:115], v[110:111]
    v_pk_fma_f32 v[112:113], v[112:113], v[12:13], v[112:113]
    v_pk_fma_f32 v[108:109], v[108:109], v[12:13], v[8:9]
    v_pk_fma_f32 v[114:115], v[114:115], v[14:15], v[114:115]
    v_pk_fma_f32 v[110:111], v[110:111], v[14:15], v[10:11]
    s_cbranch_scc0 L_B2_2
    s_branch L_T2_2
L_stub8:
    s_branch L_stub15
L_T2_1:
    v_exp_f32 v12, v32
    v_exp_f32 v13, v33
    v_exp_f32 v14, v34
    v_exp_f32 v15, v35
    v_pk_fma_f32 v[32:33], v[32:33], v[124:125], v[120:121]
    v_pk_fma_f32 v[34:35], v[34:35], v[126:127], v[122:123]
    v_pk_fma_f32 v[124:125], v[124:125], v[12:13], v[124:125]
    v_pk_fma_f32 v[120:121], v[120:121], v[12:13], v[32:33]
    v_pk_fma_f32 v[126:127], v[126:127], v[14:15], v[126:127]
    v_pk_fma_f32 v[122:123], v[122:123], v[14:15], v[34:35]
L_E3_1:
    s_mov_b32 s57, 1
    s_cmp_eq_u32 s71, 3
    s_cbranch_scc1 L_wrap1
    s_setprio 1
    s_cmp_eq_u32 s71, 6
    s_cbranch_scc1 L_E0_1
    s_setprio 0
    s_cmp_eq_u32 s71, 9
    s_cbranch_scc1 L_E0_1
    s_mov_b32 exec_hi, 0
    s_cmp_eq_u32 s71, 12
    s_cbranch_scc1 L_E0_1
    s_cmp_eq_u32 s71, 18
    s_cbranch_scc1 L_E0_1
    s_mov_b32 exec_hi, -1
    s_cmp_lg_u32 s3, s83
    s_cbranch_scc1 L_flush
    s_branch L_rs1
L_E0_2:
    v_readlane_b32 s56, v40, s71
    s_add_u32 s71, s71, 1
    s_sub_u32 s56, s56, 1
    s_cbranch_scc1 L_E1_2
    s_waitcnt lgkmcnt(1)
    v_pk_fma_f32 v[8:9], v[20:21], v[4:5], v[56:57] op_sel:[1,0,0] op_sel_hi:[1,1,1]
    v_pk_fma_f32 v[10:11], v[20:21], v[6:7], v[58:59] op_sel:[1,0,0] op_sel_hi:[1,1,1]
    v_pk_fma_f32 v[32:33], v[20:21], v[52:53], v[68:69] op_sel:[1,0,0] op_sel_hi:[1,1,1]
    v_pk_fma_f32 v[34:35], v[20:21], v[54:55], v[70:71] op_sel:[1,0,0] op_sel_hi:[1,1,1]
    s_waitcnt vmcnt(3)
    s_sub_u32 s56, s56, 1
    v_mfma_f32_4x4x4_16b_bf16 v[8:11], v[2:3], v[44:45], v[8:11]
    v_mfma_f32_4x4x4_16b_bf16 v[32:35], v[2:3], v[46:47], v[32:35]
    buffer_load_dwordx4 v[44:47], v20, s[40:43], s70 offen sc1
    s_nop 2
    v_exp_f32 v12, v8
    v_exp_f32 v13, v9
    v_exp_f32 v14, v10
    v_exp_f32 v15, v11
    v_pk_fma_f32 v[8:9], v[8:9], v[64:65], v[60:61]
    v_pk_fma_f32 v[10:11], v[10:11], v[66:67], v[62:63]
    v_pk_fma_f32 v[64:65], v[64:65], v[12:13], v[64:65]
    v_pk_fma_f32 v[60:61], v[60:61], v[12:13], v[8:9]
    v_pk_fma_f32 v[66:67], v[66:67], v[14:15], v[66:67]
    v_pk_fma_f32 v[62:63], v[62:63], v[14:15], v[10:11]
    s_cbranch_scc0 L_B0_3
    s_branch L_T0_3
L_T0_2:
    v_exp_f32 v12, v32
    v_exp_f32 v13, v33
    v_exp_f32 v14, v34
    v_exp_f32 v15, v35
    v_pk_fma_f32 v[32:33], v[32:33], v[76:77], v[72:73]
    v_pk_fma_f32 v[34:35], v[34:35], v[78:79], v[74:75]
    v_pk_fma_f32 v[76:77], v[76:77], v[12:13], v[76:77]
    v_pk_fma_f32 v[72:73], v[72:73], v[12:13], v[32:33]
    v_pk_fma_f32 v[78:79], v[78:79], v[14:15], v[78:79]
    v_pk_fma_f32 v[74:75], v[74:75], v[14:15], v[34:35]
L_E1_2:
    s_mov_b32 s57, 2
    s_cmp_eq_u32 s71, 4
    s_cbranch_scc1 L_hk1
L_H_2:
    v_readlane_b32 s56, v40, s71
    s_add_u32 s71, s71, 1
    s_sub_u32 s56, s56, 1
    s_cbranch_scc1 L_E2_2
    s_waitcnt lgkmcnt(1)
    v_pk_fma_f32 v[8:9], v[20:21], v[4:5], v[80:81] op_sel:[1,0,0] op_sel_hi:[1,1,1]
    v_pk_fma_f32 v[10:11], v[20:21], v[6:7], v[82:83] op_sel:[1,0,0] op_sel_hi:[1,1,1]
    v_pk_fma_f32 v[32:33], v[20:21], v[52:53], v[92:93] op_sel:[1,0,0] op_sel_hi:[1,1,1]
    v_pk_fma_f32 v[34:35], v[20:21], v[54:55], v[94:95] op_sel:[1,0,0] op_sel_hi:[1,1,1]
    s_waitcnt vmcnt(3)
    s_sub_u32 s56, s56, 1
    v_mfma_f32_4x4x4_16b_bf16 v[8:11], v[2:3], v[44:45], v[8:11]
    v_mfma_f32_4x4x4_16b_bf16 v[32:35], v[2:3], v[46:47], v[32:35]
    buffer_load_dwordx4 v[44:47], v20, s[40:43], s70 offen sc1
    s_nop 2
    v_exp_f32 v12, v8
    v_exp_f32 v13, v9
    v_exp_f32 v14, v10
    v_exp_f32 v15, v11
    v_pk_fma_f32 v[8:9], v[8:9], v[88:89], v[84:85]
    v_pk_fma_f32 v[10:11], v[10:11], v[90:91], v[86:87]
    v_pk_fma_f32 v[88:89], v[88:89], v[12:13], v[88:89]
    v_pk_fma_f32 v[84:85], v[84:85], v[12:13], v[8:9]
    v_pk_fma_f32 v[90:91], v[90:91], v[14:15], v[90:91]
    v_pk_fma_f32 v[86:87], v[86:87], v[14:15], v[10:11]
    s_cbranch_scc0 L_B1_3
    s_branch L_T1_3
L_T1_2:
    v_exp_f32 v12, v32
    v_exp_f32 v13, v33
    v_exp_f32 v14, v34
    v_exp_f32 v15, v35
    v_pk_fma_f32 v[32:33], v[32:33], v[100:101], v[96:97]
    v_pk_fma_f32 v[34:35], v[34:35], v[102:103], v[98:99]
    v_pk_fma_f32 v[100:101], v[100:101], v[12:13], v[100:101]
    v_pk_fma_f32 v[96:97], v[96:97], v[12:13], v[32:33]
    v_pk_fma_f32 v[102:103], v[102:103], v[14:15], v[102:103]
    v_pk_fma_f32 v[98:99], v[98:99], v[14:15], v[34:35]
L_E2_2:
    v_readlane_b32 s56, v40, s71
    s_add_u32 s71, s71, 1
    s_sub_u32 s56, s56, 1
    s_cbranch_scc1 L_E3_2
    s_waitcnt lgkmcnt(1)
    v_pk_fma_f32 v[8:9], v[20:21], v[4:5], v[104:105] op_sel:[1,0,0] op_sel_hi:[1,1,1]
    v_pk_fma_f32 v[10:11], v[20:21], v[6:7], v[106:107] op_sel:[1,0,0] op_sel_hi:[1,1,1]
    v_pk_fma_f32 v[32:33], v[20:21], v[52:53], v[116:117] op_sel:[1,0,0] op_sel_hi:[1,1,1]
    v_pk_fma_f32 v[34:35], v[20:21], v[54:55], v[118:119] op_sel:[1,0,0] op_sel_hi:[1,1,1]
    s_waitcnt vmcnt(3)
    s_sub_u32 s56, s56, 1
    v_mfma_f32_4x4x4_16b_bf16 v[8:11], v[2:3], v[44:45], v[8:11]
    v_mfma_f32_4x4x4_16b_bf16 v[32:35], v[2:3], v[46:47], v[32:35]
    buffer_load_dwordx4 v[44:47], v20, s[40:43], s70 offen sc1
    s_nop 2
    v_exp_f32 v12, v8
    v_exp_f32 v13, v9
    v_exp_f32 v14, v10
    v_exp_f32 v15, v11
    v_pk_fma_f32 v[8:9], v[8:9], v[112:113], v[108:109]
    v_pk_fma_f32 v[10:11], v[10:11], v[114:115], v[110:111]
    v_pk_fma_f32 v[112:113], v[112:113], v[12:13], v[112:113]
    v_pk_fma_f32 v[108:109], v[108:109], v[12:13], v[8:9]
    v_pk_fma_f32 v[114:115], v[114:115], v[14:15], v[114:115]
    v_pk_fma_f32 v[110:111], v[110:111], v[14:15], v[10:11]
    s_cbranch_scc0 L_B2_3
    s_branch L_T2_3
L_T2_2:
    v_exp_f32 v12, v32
    v_exp_f32 v13, v33
    v_exp_f32 v14, v34
    v_exp_f32 v15, v35
    v_pk_fma_f32 v[32:33], v[32:33], v[124:125], v[120:121]
    v_pk_fma_f32 v[34:35], v[34:35], v[126:127], v[122:123]
    v_pk_fma_f32 v[124:125], v[124:125], v[12:13], v[124:125]
    v_pk_fma_f32 v[120:121], v[120:121], v[12:13], v[32:33]
    v_pk_fma_f32 v[126:127], v[126:127], v[14:15], v[126:127]
    v_pk_fma_f32 v[122:123], v[122:123], v[14:15], v[34:35]
L_E3_2:
    s_mov_b32 s57, 2
    s_cmp_eq_u32 s71, 3
    s_cbranch_scc1 L_wrap1
    s_setprio 1
    s_cmp_eq_u32 s71, 6
    s_cbranch_scc1 L_E0_2
    s_setprio 0
    s_cmp_eq_u32 s71, 9
    s_cbranch_scc1 L_E0_2
    s_mov_b32 exec_hi, 0
    s_cmp_eq_u32 s71, 12
    s_cbranch_scc1 L_E0_2
    s_cmp_eq_u32 s71, 18
    s_cbranch_scc1 L_E0_2
    s_mov_b32 exec_hi, -1
    s_cmp_lg_u32 s3, s83
    s_cbranch_scc1 L_flush
    s_branch L_rs2
L_E0_3:
    v_readlane_b32 s56, v40, s71
    s_add_u32 s71, s71, 1
    s_sub_u32 s56, s56, 1
    s_cbranch_scc1 L_E1_3
    v_pk_fma_f32 v[8:9], v[22:23], v[4:5], v[56:57] op_sel:[1,0,0] op_sel_hi:[1,1,1]
    v_pk_fma_f32 v[10:11], v[22:23], v[6:7], v[58:59] op_sel:[1,0,0] op_sel_hi:[1,1,1]
    v_pk_fma_f32 v[32:33], v[22:23], v[52:53], v[68:69] op_sel:[1,0,0] op_sel_hi:[1,1,1]
    v_pk_fma_f32 v[34:35], v[22:23], v[54:55], v[70:71] op_sel:[1,0,0] op_sel_hi:[1,1,1]
    s_waitcnt vmcnt(3)
    s_sub_u32 s56, s56, 1
    v_mfma_f32_4x4x4_16b_bf16 v[8:11], v[2:3], v[48:49], v[8:11]
    v_mfma_f32_4x4x4_16b_bf16 v[32:35], v[2:3], v[50:51], v[32:35]
    buffer_load_dwordx4 v[48:51], v22, s[40:43], s70 offen sc1
    ds_read_b128 v[20:23], v1 offset:80
    v_add_u32 v1, 32, v1
    s_nop 0
    v_exp_f32 v12, v8
    v_exp_f32 v13, v9
    v_exp_f32 v14, v10
    v_exp_f32 v15, v11
    v_pk_fma_f32 v[8:9], v[8:9], v[64:65], v[60:61]
    v_pk_fma_f32 v[10:11], v[10:11], v[66:67], v[62:63]
    v_pk_fma_f32 v[64:65], v[64:65], v[12:13], v[64:65]
    v_pk_fma_f32 v[60:61], v[60:61], v[12:13], v[8:9]
    v_pk_fma_f32 v[66:67], v[66:67], v[14:15], v[66:67]
    v_pk_fma_f32 v[62:63], v[62:63], v[14:15], v[10:11]
    s_cbranch_scc0 L_B0_0
    s_branch L_T0_0
L_stub9:
    s_branch L_Bback
L_T0_3:
    v_exp_f32 v12, v32
    v_exp_f32 v13, v33
    v_exp_f32 v14, v34
    v_exp_f32 v15, v35
    v_pk_fma_f32 v[32:33], v[32:33], v[76:77], v[72:73]
    v_pk_fma_f32 v[34:35], v[34:35], v[78:79], v[74:75]
    v_pk_fma_f32 v[76:77], v[76:77], v[12:13], v[76:77]
    v_pk_fma_f32 v[72:73], v[72:73], v[12:13], v[32:33]
    v_pk_fma_f32 v[78:79], v[78:79], v[14:15], v[78:79]
    v_pk_fma_f32 v[74:75], v[74:75], v[14:15], v[34:35]
L_E1_3:
    s_mov_b32 s57, 3
    s_cmp_eq_u32 s71, 4
    s_cbranch_scc1 L_hk1
L_H_3:
    v_readlane_b32 s56, v40, s71
    s_add_u32 s71, s71, 1
    s_sub_u32 s56, s56, 1
    s_cbranch_scc1 L_E2_3
    v_pk_fma_f32 v[8:9], v[22:23], v[4:5], v[80:81] op_sel:[1,0,0] op_sel_hi:[1,1,1]
    v_pk_fma_f32 v[10:11], v[22:23], v[6:7], v[82:83] op_sel:[1,0,0] op_sel_hi:[1,1,1]
    v_pk_fma_f32 v[32:33], v[22:23], v[52:53], v[92:93] op_sel:[1,0,0] op_sel_hi:[1,1,1]
    v_pk_fma_f32 v[34:35], v[22:23], v[54:55], v[94:95] op_sel:[1,0,0] op_sel_hi:[1,1,1]
    s_waitcnt vmcnt(3)
    s_sub_u32 s56, s56, 1
    v_mfma_f32_4x4x4_16b_bf16 v[8:11], v[2:3], v[48:49], v[8:11]
    v_mfma_f32_4x4x4_16b_bf16 v[32:35], v[2:3], v[50:51], v[32:35]
    buffer_load_dwordx4 v[48:51], v22, s[40:43], s70 offen sc1
    ds_read_b128 v[20:23], v1 offset:80
    v_add_u32 v1, 32, v1
    s_nop 0
    v_exp_f32 v12, v8
    v_exp_f32 v13, v9
    v_exp_f32 v14, v10
    v_exp_f32 v15, v11
    v_pk_fma_f32 v[8:9], v[8:9], v[88:89], v[84:85]
    v_pk_fma_f32 v[10:11], v[10:11], v[90:91], v[86:87]
    v_pk_fma_f32 v[88:89], v[88:89], v[12:13], v[88:89]
    v_pk_fma_f32 v[84:85], v[84:85], v[12:13], v[8:9]
    v_pk_fma_f32 v[90:91], v[90:91], v[14:15], v[90:91]
    v_pk_fma_f32 v[86:87], v[86:87], v[14:15], v[10:11]
    s_cbranch_scc0 L_B1_0
    s_branch L_T1_0
L_T1_3:
    v_exp_f32 v12, v32
    v_exp_f32 v13, v33
    v_exp_f32 v14, v34
    v_exp_f32 v15, v35
    v_pk_fma_f32 v[32:33], v[32:33], v[100:101], v[96:97]
    v_pk_fma_f32 v[34:35], v[34:35], v[102:103], v[98:99]
    v_pk_fma_f32 v[100:101], v[100:101], v[12:13], v[100:101]
    v_pk_fma_f32 v[96:97], v[96:97], v[12:13], v[32:33]
    v_pk_fma_f32 v[102:103], v[102:103], v[14:15], v[102:103]
    v_pk_fma_f32 v[98:99], v[98:99], v[14:15], v[34:35]
L_E2_3:
    v_readlane_b32 s56, v40, s71
    s_add_u32 s71, s71, 1
    s_sub_u32 s56, s56, 1
    s_cbranch_scc1 L_E3_3
    v_pk_fma_f32 v[8:9], v[22:23], v[4:5], v[104:105] op_sel:[1,0,0] op_sel_hi:[1,1,1]
    v_pk_fma_f32 v[10:11], v[22:23], v[6:7], v[106:107] op_sel:[1,0,0] op_sel_hi:[1,1,1]
    v_pk_fma_f32 v[32:33], v[22:23], v[52:53], v[116:117] op_sel:[1,0,0] op_sel_hi:[1,1,1]
    v_pk_fma_f32 v[34:35], v[22:23], v[54:55], v[118:119] op_sel:[1,0,0] op_sel_hi:[1,1,1]
    s_waitcnt vmcnt(3)
    s_sub_u32 s56, s56, 1
    v_mfma_f32_4x4x4_16b_bf16 v[8:11], v[2:3], v[48:49], v[8:11]
    v_mfma_f32_4x4x4_16b_bf16 v[32:35], v[2:3], v[50:51], v[32:35]
    buffer_load_dwordx4 v[48:51], v22, s[40:43], s70 offen sc1
    ds_read_b128 v[20:23], v1 offset:80
    v_add_u32 v1, 32, v1
    s_nop 0
    v_exp_f32 v12, v8
    v_exp_f32 v13, v9
    v_exp_f32 v14, v10
    v_exp_f32 v15, v11
    v_pk_fma_f32 v[8:9], v[8:9], v[112:113], v[108:109]
    v_pk_fma_f32 v[10:11], v[10:11], v[114:115], v[110:111]
    v_pk_fma_f32 v[112:113], v[112:113], v[12:13], v[112:113]
    v_pk_fma_f32 v[108:109], v[108:109], v[12:13], v[8:9]
    v_pk_fma_f32 v[114:115], v[114:115], v[14:15], v[114:115]
    v_pk_fma_f32 v[110:111], v[110:111], v[14:15], v[10:11]
    s_cbranch_scc0 L_B2_0
    s_branch L_T2_0
L_T2_3:
    v_exp_f32 v12, v32
    v_exp_f32 v13, v33
    v_exp_f32 v14, v34
    v_exp_f32 v15, v35
    v_pk_fma_f32 v[32:33], v[32:33], v[124:125], v[120:121]
    v_pk_fma_f32 v[34:35], v[34:35], v[126:127], v[122:123]
    v_pk_fma_f32 v[124:125], v[124:125], v[12:13], v[124:125]
    v_pk_fma_f32 v[120:121], v[120:121], v[12:13], v[32:33]
    v_pk_fma_f32 v[126:127], v[126:127], v[14:15], v[126:127]
    v_pk_fma_f32 v[122:123], v[122:123], v[14:15], v[34:35]
L_E3_3:
    s_mov_b32 s57, 3
    s_cmp_eq_u32 s71, 3
    s_cbranch_scc1 L_wrap1
    s_setprio 1
    s_cmp_eq_u32 s71, 6
    s_cbranch_scc1 L_E0_3
    s_setprio 0
    s_cmp_eq_u32 s71, 9
    s_cbranch_scc1 L_E0_3
    s_mov_b32 exec_hi, 0
    s_cmp_eq_u32 s71, 12
    s_cbranch_scc1 L_E0_3
    s_cmp_eq_u32 s71, 18
    s_cbranch_scc1 L_E0_3
    s_mov_b32 exec_hi, -1
    s_cmp_lg_u32 s3, s83
    s_cbranch_scc1 L_flush
    s_branch L_rs3
L_stub10:
    s_branch L_Bback
L_B0_0:
    s_waitcnt lgkmcnt(1)
    v_pk_fma_f32 v[8:9], v[16:17], v[4:5], v[56:57] op_sel:[1,0,0] op_sel_hi:[1,1,1]
    v_pk_fma_f32 v[10:11], v[16:17], v[6:7], v[58:59] op_sel:[1,0,0] op_sel_hi:[1,1,1]
    s_waitcnt vmcnt(3)
    s_sub_u32 s56, s56, 1
    v_mfma_f32_4x4x4_16b_bf16 v[8:11], v[2:3], v[24:25], v[8:11]
    v_exp_f32 v12, v32
    v_exp_f32 v13, v33
    v_exp_f32 v14, v34
    v_exp_f32 v15, v35
    v_pk_fma_f32 v[32:33], v[32:33], v[76:77], v[72:73]
    v_pk_fma_f32 v[34:35], v[34:35], v[78:79], v[74:75]
    v_pk_fma_f32 v[76:77], v[76:77], v[12:13], v[76:77]
    v_pk_fma_f32 v[72:73], v[72:73], v[12:13], v[32:33]
    v_pk_fma_f32 v[78:79], v[78:79], v[14:15], v[78:79]
    v_pk_fma_f32 v[74:75], v[74:75], v[14:15], v[34:35]
    v_pk_fma_f32 v[32:33], v[16:17], v[52:53], v[68:69] op_sel:[1,0,0] op_sel_hi:[1,1,1]
    v_pk_fma_f32 v[34:35], v[16:17], v[54:55], v[70:71] op_sel:[1,0,0] op_sel_hi:[1,1,1]
    v_exp_f32 v12, v8
    v_exp_f32 v13, v9
    v_mfma_f32_4x4x4_16b_bf16 v[32:35], v[2:3], v[26:27], v[32:35]
    buffer_load_dwordx4 v[24:27], v16, s[40:43], s70 offen sc1
    v_exp_f32 v14, v10
    v_exp_f32 v15, v11
    v_pk_fma_f32 v[8:9], v[8:9], v[64:65], v[60:61]
    v_pk_fma_f32 v[10:11], v[10:11], v[66:67], v[62:63]
    v_pk_fma_f32 v[64:65], v[64:65], v[12:13], v[64:65]
    v_pk_fma_f32 v[60:61], v[60:61], v[12:13], v[8:9]
    v_pk_fma_f32 v[66:67], v[66:67], v[14:15], v[66:67]
    v_pk_fma_f32 v[62:63], v[62:63], v[14:15], v[10:11]
    s_cbranch_scc1 L_T0_1
L_B0_1:
    v_pk_fma_f32 v[8:9], v[18:19], v[4:5], v[56:57] op_sel:[1,0,0] op_sel_hi:[1,1,1]
    v_pk_fma_f32 v[10:11], v[18:19], v[6:7], v[58:59] op_sel:[1,0,0] op_sel_hi:[1,1,1]
    s_waitcnt vmcnt(3)
    s_sub_u32 s56, s56, 1
    v_mfma_f32_4x4x4_16b_bf16 v[8:11], v[2:3], v[28:29], v[8:11]
    v_exp_f32 v12, v32
    v_exp_f32 v13, v33
    v_exp_f32 v14, v34
    v_exp_f32 v15, v35
    v_pk_fma_f32 v[32:33], v[32:33], v[76:77], v[72:73]
    v_pk_fma_f32 v[34:35], v[34:35], v[78:79], v[74:75]
    v_pk_fma_f32 v[76:77], v[76:77], v[12:13], v[76:77]
    v_pk_fma_f32 v[72:73], v[72:73], v[12:13], v[32:33]
    v_pk_fma_f32 v[78:79], v[78:79], v[14:15], v[78:79]
    v_pk_fma_f32 v[74:75], v[74:75], v[14:15], v[34:35]
    v_pk_fma_f32 v[32:33], v[18:19], v[52:53], v[68:69] op_sel:[1,0,0] op_sel_hi:[1,1,1]
    v_pk_fma_f32 v[34:35], v[18:19], v[54:55], v[70:71] op_sel:[1,0,0] op_sel_hi:[1,1,1]
    v_exp_f32 v12, v8
    v_exp_f32 v13, v9
    v_mfma_f32_4x4x4_16b_bf16 v[32:35], v[2:3], v[30:31], v[32:35]
    buffer_load_dwordx4 v[28:31], v18, s[40:43], s70 offen sc1
    ds_read_b128 v[16:19], v1 offset:64
    v_exp_f32 v14, v10
    v_exp_f32 v15, v11
    v_pk_fma_f32 v[8:9], v[8:9], v[64:65], v[60:61]
    v_pk_fma_f32 v[10:11], v[10:11], v[66:67], v[62:63]
    v_pk_fma_f32 v[64:65], v[64:65], v[12:13], v[64:65]
    v_pk_fma_f32 v[60:61], v[60:61], v[12:13], v[8:9]
    v_pk_fma_f32 v[66:67], v[66:67], v[14:15], v[66:67]
    v_pk_fma_f32 v[62:63], v[62:63], v[14:15], v[10:11]
    s_cbranch_scc1 L_T0_2
L_B0_2:
    s_waitcnt lgkmcnt(1)
    v_pk_fma_f32 v[8:9], v[20:21], v[4:5], v[56:57] op_sel:[1,0,0] op_sel_hi:[1,1,1]
    v_pk_fma_f32 v[10:11], v[20:21], v[6:7], v[58:59] op_sel:[1,0,0] op_sel_hi:[1,1,1]
    s_waitcnt vmcnt(3)
    s_sub_u32 s56, s56, 1
    v_mfma_f32_4x4x4_16b_bf16 v[8:11], v[2:3], v[44:45], v[8:11]
    v_exp_f32 v12, v32
    v_exp_f32 v13, v33
    v_exp_f32 v14, v34
    v_exp_f32 v15, v35
    v_pk_fma_f32 v[32:33], v[32:33], v[76:77], v[72:73]
    v_pk_fma_f32 v[34:35], v[34:35], v[78:79], v[74:75]
    v_pk_fma_f32 v[76:77], v[76:77], v[12:13], v[76:77]
    v_pk_fma_f32 v[72:73], v[72:73], v[12:13], v[32:33]
    v_pk_fma_f32 v[78:79], v[78:79], v[14:15], v[78:79]
    v_pk_fma_f32 v[74:75], v[74:75], v[14:15], v[34:35]
    v_pk_fma_f32 v[32:33], v[20:21], v[52:53], v[68:69] op_sel:[1,0,0] op_sel_hi:[1,1,1]
    v_pk_fma_f32 v[34:35], v[20:21], v[54:55], v[70:71] op_sel:[1,0,0] op_sel_hi:[1,1,1]
    v_exp_f32 v12, v8
    v_exp_f32 v13, v9
    v_mfma_f32_4x4x4_16b_bf16 v[32:35], v[2:3], v[46:47], v[32:35]
    buffer_load_dwordx4 v[44:47], v20, s[40:43], s70 offen sc1
    v_exp_f32 v14, v10
    v_exp_f32 v15, v11
    v_pk_fma_f32 v[8:9], v[8:9], v[64:65], v[60:61]
    v_pk_fma_f32 v[10:11], v[10:11], v[66:67], v[62:63]
    v_pk_fma_f32 v[64:65], v[64:65], v[12:13], v[64:65]
    v_pk_fma_f32 v[60:61], v[60:61], v[12:13], v[8:9]
    v_pk_fma_f32 v[66:67], v[66:67], v[14:15], v[66:67]
    v_pk_fma_f32 v[62:63], v[62:63], v[14:15], v[10:11]
    s_cbranch_scc1 L_T0_3
L_B0_3:
    v_pk_fma_f32 v[8:9], v[22:23], v[4:5], v[56:57] op_sel:[1,0,0] op_sel_hi:[1,1,1]
    v_pk_fma_f32 v[10:11], v[22:23], v[6:7], v[58:59] op_sel:[1,0,0] op_sel_hi:[1,1,1]
    s_waitcnt vmcnt(3)
    s_sub_u32 s56, s56, 1
    v_mfma_f32_4x4x4_16b_bf16 v[8:11], v[2:3], v[48:49], v[8:11]
    v_exp_f32 v12, v32
    v_exp_f32 v13, v33
    v_exp_f32 v14, v34
    v_exp_f32 v15, v35
    v_pk_fma_f32 v[32:33], v[32:33], v[76:77], v[72:73]
    v_pk_fma_f32 v[34:35], v[34:35], v[78:79], v[74:75]
    v_pk_fma_f32 v[76:77], v[76:77], v[12:13], v[76:77]
    v_pk_fma_f32 v[72:73], v[72:73], v[12:13], v[32:33]
    v_pk_fma_f32 v[78:79], v[78:79], v[14:15], v[78:79]
    v_pk_fma_f32 v[74:75], v[74:75], v[14:15], v[34:35]
    v_pk_fma_f32 v[32:33], v[22:23], v[52:53], v[68:69] op_sel:[1,0,0] op_sel_hi:[1,1,1]
    v_pk_fma_f32 v[34:35], v[22:23], v[54:55], v[70:71] op_sel:[1,0,0] op_sel_hi:[1,1,1]
    v_exp_f32 v12, v8
    v_exp_f32 v13, v9
    v_mfma_f32_4x4x4_16b_bf16 v[32:35], v[2:3], v[50:51], v[32:35]
    buffer_load_dwordx4 v[48:51], v22, s[40:43], s70 offen sc1
    ds_read_b128 v[20:23], v1 offset:80
    v_add_u32 v1, 32, v1
    v_exp_f32 v14, v10
    v_exp_f32 v15, v11
    v_pk_fma_f32 v[8:9], v[8:9], v[64:65], v[60:61]
    v_pk_fma_f32 v[10:11], v[10:11], v[66:67], v[62:63]
    v_pk_fma_f32 v[64:65], v[64:65], v[12:13], v[64:65]
    v_pk_fma_f32 v[60:61], v[60:61], v[12:13], v[8:9]
    v_pk_fma_f32 v[66:67], v[66:67], v[14:15], v[66:67]
    v_pk_fma_f32 v[62:63], v[62:63], v[14:15], v[10:11]
    s_cbranch_scc1 L_T0_0
    s_branch L_B0_0
L_stub11:
    s_branch L_Bback
L_B1_0:
    s_waitcnt lgkmcnt(1)
    v_pk_fma_f32 v[8:9], v[16:17], v[4:5], v[80:81] op_sel:[1,0,0] op_sel_hi:[1,1,1]
    v_pk_fma_f32 v[10:11], v[16:17], v[6:7], v[82:83] op_sel:[1,0,0] op_sel_hi:[1,1,1]
    s_waitcnt vmcnt(3)
    s_sub_u32 s56, s56, 1
    v_mfma_f32_4x4x4_16b_bf16 v[8:11], v[2:3], v[24:25], v[8:11]
    v_exp_f32 v12, v32
    v_exp_f32 v13, v33
    v_exp_f32 v14, v34
    v_exp_f32 v15, v35
    v_pk_fma_f32 v[32:33], v[32:33], v[100:101], v[96:97]
    v_pk_fma_f32 v[34:35], v[34:35], v[102:103], v[98:99]
    v_pk_fma_f32 v[100:101], v[100:101], v[12:13], v[100:101]
    v_pk_fma_f32 v[96:97], v[96:97], v[12:13], v[32:33]
    v_pk_fma_f32 v[102:103], v[102:103], v[14:15], v[102:103]
    v_pk_fma_f32 v[98:99], v[98:99], v[14:15], v[34:35]
    v_pk_fma_f32 v[32:33], v[16:17], v[52:53], v[92:93] op_sel:[1,0,0] op_sel_hi:[1,1,1]
    v_pk_fma_f32 v[34:35], v[16:17], v[54:55], v[94:95] op_sel:[1,0,0] op_sel_hi:[1,1,1]
    v_exp_f32 v12, v8
    v_exp_f32 v13, v9
    v_mfma_f32_4x4x4_16b_bf16 v[32:35], v[2:3], v[26:27], v[32:35]
    buffer_load_dwordx4 v[24:27], v16, s[40:43], s70 offen sc1
    v_exp_f32 v14, v10
    v_exp_f32 v15, v11
    v_pk_fma_f32 v[8:9], v[8:9], v[88:89], v[84:85]
    v_pk_fma_f32 v[10:11], v[10:11], v[90:91], v[86:87]
    v_pk_fma_f32 v[88:89], v[88:89], v[12:13], v[88:89]
    v_pk_fma_f32 v[84:85], v[84:85], v[12:13], v[8:9]
    v_pk_fma_f32 v[90:91], v[90:91], v[14:15], v[90:91]
    v_pk_fma_f32 v[86:87], v[86:87], v[14:15], v[10:11]
    s_cbranch_scc1 L_T1_1
L_B1_1:
    v_pk_fma_f32 v[8:9], v[18:19], v[4:5], v[80:81] op_sel:[1,0,0] op_sel_hi:[1,1,1]
    v_pk_fma_f32 v[10:11], v[18:19], v[6:7], v[82:83] op_sel:[1,0,0] op_sel_hi:[1,1,1]
    s_waitcnt vmcnt(3)
    s_sub_u32 s56, s56, 1
    v_mfma_f32_4x4x4_16b_bf16 v[8:11], v[2:3], v[28:29], v[8:11]
    v_exp_f32 v12, v32
    v_exp_f32 v13, v33
    v_exp_f32 v14, v34
    v_exp_f32 v15, v35
    v_pk_fma_f32 v[32:33], v[32:33], v[100:101], v[96:97]
    v_pk_fma_f32 v[34:35], v[34:35], v[102:103], v[98:99]
    v_pk_fma_f32 v[100:101], v[100:101], v[12:13], v[100:101]
    v_pk_fma_f32 v[96:97], v[96:97], v[12:13], v[32:33]
    v_pk_fma_f32 v[102:103], v[102:103], v[14:15], v[102:103]
    v_pk_fma_f32 v[98:99], v[98:99], v[14:15], v[34:35]
    v_pk_fma_f32 v[32:33], v[18:19], v[52:53], v[92:93] op_sel:[1,0,0] op_sel_hi:[1,1,1]
    v_pk_fma_f32 v[34:35], v[18:19], v[54:55], v[94:95] op_sel:[1,0,0] op_sel_hi:[1,1,1]
    v_exp_f32 v12, v8
    v_exp_f32 v13, v9
    v_mfma_f32_4x4x4_16b_bf16 v[32:35], v[2:3], v[30:31], v[32:35]
    buffer_load_dwordx4 v[28:31], v18, s[40:43], s70 offen sc1
    ds_read_b128 v[16:19], v1 offset:64
    v_exp_f32 v14, v10
    v_exp_f32 v15, v11
    v_pk_fma_f32 v[8:9], v[8:9], v[88:89], v[84:85]
    v_pk_fma_f32 v[10:11], v[10:11], v[90:91], v[86:87]
    v_pk_fma_f32 v[88:89], v[88:89], v[12:13], v[88:89]
    v_pk_fma_f32 v[84:85], v[84:85], v[12:13], v[8:9]
    v_pk_fma_f32 v[90:91], v[90:91], v[14:15], v[90:91]
    v_pk_fma_f32 v[86:87], v[86:87], v[14:15], v[10:11]
    s_cbranch_scc1 L_T1_2
L_B1_2:
    s_waitcnt lgkmcnt(1)
    v_pk_fma_f32 v[8:9], v[20:21], v[4:5], v[80:81] op_sel:[1,0,0] op_sel_hi:[1,1,1]
    v_pk_fma_f32 v[10:11], v[20:21], v[6:7], v[82:83] op_sel:[1,0,0] op_sel_hi:[1,1,1]
    s_waitcnt vmcnt(3)
    s_sub_u32 s56, s56, 1
    v_mfma_f32_4x4x4_16b_bf16 v[8:11], v[2:3], v[44:45], v[8:11]
    v_exp_f32 v12, v32
    v_exp_f32 v13, v33
    v_exp_f32 v14, v34
    v_exp_f32 v15, v35
    v_pk_fma_f32 v[32:33], v[32:33], v[100:101], v[96:97]
    v_pk_fma_f32 v[34:35], v[34:35], v[102:103], v[98:99]
    v_pk_fma_f32 v[100:101], v[100:101], v[12:13], v[100:101]
    v_pk_fma_f32 v[96:97], v[96:97], v[12:13], v[32:33]
    v_pk_fma_f32 v[102:103], v[102:103], v[14:15], v[102:103]
    v_pk_fma_f32 v[98:99], v[98:99], v[14:15], v[34:35]
    v_pk_fma_f32 v[32:33], v[20:21], v[52:53], v[92:93] op_sel:[1,0,0] op_sel_hi:[1,1,1]
    v_pk_fma_f32 v[34:35], v[20:21], v[54:55], v[94:95] op_sel:[1,0,0] op_sel_hi:[1,1,1]
    v_exp_f32 v12, v8
    v_exp_f32 v13, v9
    v_mfma_f32_4x4x4_16b_bf16 v[32:35], v[2:3], v[46:47], v[32:35]
    buffer_load_dwordx4 v[44:47], v20, s[40:43], s70 offen sc1
    v_exp_f32 v14, v10
    v_exp_f32 v15, v11
    v_pk_fma_f32 v[8:9], v[8:9], v[88:89], v[84:85]
    v_pk_fma_f32 v[10:11], v[10:11], v[90:91], v[86:87]
    v_pk_fma_f32 v[88:89], v[88:89], v[12:13], v[88:89]
    v_pk_fma_f32 v[84:85], v[84:85], v[12:13], v[8:9]
    v_pk_fma_f32 v[90:91], v[90:91], v[14:15], v[90:91]
    v_pk_fma_f32 v[86:87], v[86:87], v[14:15], v[10:11]
    s_cbranch_scc1 L_T1_3
L_B1_3:
    v_pk_fma_f32 v[8:9], v[22:23], v[4:5], v[80:81] op_sel:[1,0,0] op_sel_hi:[1,1,1]
    v_pk_fma_f32 v[10:11], v[22:23], v[6:7], v[82:83] op_sel:[1,0,0] op_sel_hi:[1,1,1]
    s_waitcnt vmcnt(3)
    s_sub_u32 s56, s56, 1
    v_mfma_f32_4x4x4_16b_bf16 v[8:11], v[2:3], v[48:49], v[8:11]
    v_exp_f32 v12, v32
    v_exp_f32 v13, v33
    v_exp_f32 v14, v34
    v_exp_f32 v15, v35
    v_pk_fma_f32 v[32:33], v[32:33], v[100:101], v[96:97]
    v_pk_fma_f32 v[34:35], v[34:35], v[102:103], v[98:99]
    v_pk_fma_f32 v[100:101], v[100:101], v[12:13], v[100:101]
    v_pk_fma_f32 v[96:97], v[96:97], v[12:13], v[32:33]
    v_pk_fma_f32 v[102:103], v[102:103], v[14:15], v[102:103]
    v_pk_fma_f32 v[98:99], v[98:99], v[14:15], v[34:35]
    v_pk_fma_f32 v[32:33], v[22:23], v[52:53], v[92:93] op_sel:[1,0,0] op_sel_hi:[1,1,1]
    v_pk_fma_f32 v[34:35], v[22:23], v[54:55], v[94:95] op_sel:[1,0,0] op_sel_hi:[1,1,1]
    v_exp_f32 v12, v8
    v_exp_f32 v13, v9
    v_mfma_f32_4x4x4_16b_bf16 v[32:35], v[2:3], v[50:51], v[32:35]
    buffer_load_dwordx4 v[48:51], v22, s[40:43], s70 offen sc1
    ds_read_b128 v[20:23], v1 offset:80
    v_add_u32 v1, 32, v1
    v_exp_f32 v14, v10
    v_exp_f32 v15, v11
    v_pk_fma_f32 v[8:9], v[8:9], v[88:89], v[84:85]
    v_pk_fma_f32 v[10:11], v[10:11], v[90:91], v[86:87]
    v_pk_fma_f32 v[88:89], v[88:89], v[12:13], v[88:89]
    v_pk_fma_f32 v[84:85], v[84:85], v[12:13], v[8:9]
    v_pk_fma_f32 v[90:91], v[90:91], v[14:15], v[90:91]
    v_pk_fma_f32 v[86:87], v[86:87], v[14:15], v[10:11]
    s_cbranch_scc1 L_T1_0
    s_branch L_B1_0
L_stub12:
    s_branch L_Bback
L_B2_0:
    s_waitcnt lgkmcnt(1)
    v_pk_fma_f32 v[8:9], v[16:17], v[4:5], v[104:105] op_sel:[1,0,0] op_sel_hi:[1,1,1]
    v_pk_fma_f32 v[10:11], v[16:17], v[6:7], v[106:107] op_sel:[1,0,0] op_sel_hi:[1,1,1]
    s_waitcnt vmcnt(3)
    s_sub_u32 s56, s56, 1
    v_mfma_f32_4x4x4_16b_bf16 v[8:11], v[2:3], v[24:25], v[8:11]
    v_exp_f32 v12, v32
    v_exp_f32 v13, v33
    v_exp_f32 v14, v34
    v_exp_f32 v15, v35
    v_pk_fma_f32 v[32:33], v[32:33], v[124:125], v[120:121]
    v_pk_fma_f32 v[34:35], v[34:35], v[126:127], v[122:123]
    v_pk_fma_f32 v[124:125], v[124:125], v[12:13], v[124:125]
    v_pk_fma_f32 v[120:121], v[120:121], v[12:13], v[32:33]
    v_pk_fma_f32 v[126:127], v[126:127], v[14:15], v[126:127]
    v_pk_fma_f32 v[122:123], v[122:123], v[14:15], v[34:35]
    v_pk_fma_f32 v[32:33], v[16:17], v[52:53], v[116:117] op_sel:[1,0,0] op_sel_hi:[1,1,1]
    v_pk_fma_f32 v[34:35], v[16:17], v[54:55], v[118:119] op_sel:[1,0,0] op_sel_hi:[1,1,1]
    v_exp_f32 v12, v8
    v_exp_f32 v13, v9
    v_mfma_f32_4x4x4_16b_bf16 v[32:35], v[2:3], v[26:27], v[32:35]
    buffer_load_dwordx4 v[24:27], v16, s[40:43], s70 offen sc1
    v_exp_f32 v14, v10
    v_exp_f32 v15, v11
    v_pk_fma_f32 v[8:9], v[8:9], v[112:113], v[108:109]
    v_pk_fma_f32 v[10:11], v[10:11], v[114:115], v[110:111]
    v_pk_fma_f32 v[112:113], v[112:113], v[12:13], v[112:113]
    v_pk_fma_f32 v[108:109], v[108:109], v[12:13], v[8:9]
    v_pk_fma_f32 v[114:115], v[114:115], v[14:15], v[114:115]
    v_pk_fma_f32 v[110:111], v[110:111], v[14:15], v[10:11]
    s_cbranch_scc1 L_T2_1
L_B2_1:
    v_pk_fma_f32 v[8:9], v[18:19], v[4:5], v[104:105] op_sel:[1,0,0] op_sel_hi:[1,1,1]
    v_pk_fma_f32 v[10:11], v[18:19], v[6:7], v[106:107] op_sel:[1,0,0] op_sel_hi:[1,1,1]
    s_waitcnt vmcnt(3)
    s_sub_u32 s56, s56, 1
    v_mfma_f32_4x4x4_16b_bf16 v[8:11], v[2:3], v[28:29], v[8:11]
    v_exp_f32 v12, v32
    v_exp_f32 v13, v33
    v_exp_f32 v14, v34
    v_exp_f32 v15, v35
    v_pk_fma_f32 v[32:33], v[32:33], v[124:125], v[120:121]
    v_pk_fma_f32 v[34:35], v[34:35], v[126:127], v[122:123]
    v_pk_fma_f32 v[124:125], v[124:125], v[12:13], v[124:125]
    v_pk_fma_f32 v[120:121], v[120:121], v[12:13], v[32:33]
    v_pk_fma_f32 v[126:127], v[126:127], v[14:15], v[126:127]
    v_pk_fma_f32 v[122:123], v[122:123], v[14:15], v[34:35]
    v_pk_fma_f32 v[32:33], v[18:19], v[52:53], v[116:117] op_sel:[1,0,0] op_sel_hi:[1,1,1]
    v_pk_fma_f32 v[34:35], v[18:19], v[54:55], v[118:119] op_sel:[1,0,0] op_sel_hi:[1,1,1]
    v_exp_f32 v12, v8
    v_exp_f32 v13, v9
    v_mfma_f32_4x4x4_16b_bf16 v[32:35], v[2:3], v[30:31], v[32:35]
    buffer_load_dwordx4 v[28:31], v18, s[40:43], s70 offen sc1
    ds_read_b128 v[16:19], v1 offset:64
    v_exp_f32 v14, v10
    v_exp_f32 v15, v11
    v_pk_fma_f32 v[8:9], v[8:9], v[112:113], v[108:109]
    v_pk_fma_f32 v[10:11], v[10:11], v[114:115], v[110:111]
    v_pk_fma_f32 v[112:113], v[112:113], v[12:13], v[112:113]
    v_pk_fma_f32 v[108:109], v[108:109], v[12:13], v[8:9]
    v_pk_fma_f32 v[114:115], v[114:115], v[14:15], v[114:115]
    v_pk_fma_f32 v[110:111], v[110:111], v[14:15], v[10:11]
    s_cbranch_scc1 L_T2_2
L_B2_2:
    s_waitcnt lgkmcnt(1)
    v_pk_fma_f32 v[8:9], v[20:21], v[4:5], v[104:105] op_sel:[1,0,0] op_sel_hi:[1,1,1]
    v_pk_fma_f32 v[10:11], v[20:21], v[6:7], v[106:107] op_sel:[1,0,0] op_sel_hi:[1,1,1]
    s_waitcnt vmcnt(3)
    s_sub_u32 s56, s56, 1
    v_mfma_f32_4x4x4_16b_bf16 v[8:11], v[2:3], v[44:45], v[8:11]
    v_exp_f32 v12, v32
    v_exp_f32 v13, v33
    v_exp_f32 v14, v34
    v_exp_f32 v15, v35
    v_pk_fma_f32 v[32:33], v[32:33], v[124:125], v[120:121]
    v_pk_fma_f32 v[34:35], v[34:35], v[126:127], v[122:123]
    v_pk_fma_f32 v[124:125], v[124:125], v[12:13], v[124:125]
    v_pk_fma_f32 v[120:121], v[120:121], v[12:13], v[32:33]
    v_pk_fma_f32 v[126:127], v[126:127], v[14:15], v[126:127]
    v_pk_fma_f32 v[122:123], v[122:123], v[14:15], v[34:35]
    v_pk_fma_f32 v[32:33], v[20:21], v[52:53], v[116:117] op_sel:[1,0,0] op_sel_hi:[1,1,1]
    v_pk_fma_f32 v[34:35], v[20:21], v[54:55], v[118:119] op_sel:[1,0,0] op_sel_hi:[1,1,1]
    v_exp_f32 v12, v8
    v_exp_f32 v13, v9
    v_mfma_f32_4x4x4_16b_bf16 v[32:35], v[2:3], v[46:47], v[32:35]
    buffer_load_dwordx4 v[44:47], v20, s[40:43], s70 offen sc1
    v_exp_f32 v14, v10
    v_exp_f32 v15, v11
    v_pk_fma_f32 v[8:9], v[8:9], v[112:113], v[108:109]
    v_pk_fma_f32 v[10:11], v[10:11], v[114:115], v[110:111]
    v_pk_fma_f32 v[112:113], v[112:113], v[12:13], v[112:113]
    v_pk_fma_f32 v[108:109], v[108:109], v[12:13], v[8:9]
    v_pk_fma_f32 v[114:115], v[114:115], v[14:15], v[114:115]
    v_pk_fma_f32 v[110:111], v[110:111], v[14:15], v[10:11]
    s_cbranch_scc1 L_T2_3
L_B2_3:
    v_pk_fma_f32 v[8:9], v[22:23], v[4:5], v[104:105] op_sel:[1,0,0] op_sel_hi:[1,1,1]
    v_pk_fma_f32 v[10:11], v[22:23], v[6:7], v[106:107] op_sel:[1,0,0] op_sel_hi:[1,1,1]
    s_waitcnt vmcnt(3)
    s_sub_u32 s56, s56, 1
    v_mfma_f32_4x4x4_16b_bf16 v[8:11], v[2:3], v[48:49], v[8:11]
    v_exp_f32 v12, v32
    v_exp_f32 v13, v33
    v_exp_f32 v14, v34
    v_exp_f32 v15, v35
    v_pk_fma_f32 v[32:33], v[32:33], v[124:125], v[120:121]
    v_pk_fma_f32 v[34:35], v[34:35], v[126:127], v[122:123]
    v_pk_fma_f32 v[124:125], v[124:125], v[12:13], v[124:125]
    v_pk_fma_f32 v[120:121], v[120:121], v[12:13], v[32:33]
    v_pk_fma_f32 v[126:127], v[126:127], v[14:15], v[126:127]
    v_pk_fma_f32 v[122:123], v[122:123], v[14:15], v[34:35]
    v_pk_fma_f32 v[32:33], v[22:23], v[52:53], v[116:117] op_sel:[1,0,0] op_sel_hi:[1,1,1]
    v_pk_fma_f32 v[34:35], v[22:23], v[54:55], v[118:119] op_sel:[1,0,0] op_sel_hi:[1,1,1]
    v_exp_f32 v12, v8
    v_exp_f32 v13, v9
    v_mfma_f32_4x4x4_16b_bf16 v[32:35], v[2:3], v[50:51], v[32:35]
    buffer_load_dwordx4 v[48:51], v22, s[40:43], s70 offen sc1
    ds_read_b128 v[20:23], v1 offset:80
    v_add_u32 v1, 32, v1
    v_exp_f32 v14, v10
    v_exp_f32 v15, v11
    v_pk_fma_f32 v[8:9], v[8:9], v[112:113], v[108:109]
    v_pk_fma_f32 v[10:11], v[10:11], v[114:115], v[110:111]
    v_pk_fma_f32 v[112:113], v[112:113], v[12:13], v[112:113]
    v_pk_fma_f32 v[108:109], v[108:109], v[12:13], v[8:9]
    v_pk_fma_f32 v[114:115], v[114:115], v[14:15], v[114:115]
    v_pk_fma_f32 v[110:111], v[110:111], v[14:15], v[10:11]
    s_cbranch_scc1 L_T2_0
    s_branch L_B2_0
L_stub13:
    s_branch L_Bback
L_hk1:
    s_mov_b64 exec, 1
    v_mov_b32 v43, 1
    s_waitcnt vmcnt(0)
    ds_add_u32 v42, v43 offset:16
    s_mov_b64 exec, -1
    s_cmp_eq_u32 s57, 0
    s_cbranch_scc1 L_H_0
    s_cmp_eq_u32 s57, 1
    s_cbranch_scc1 L_H_1
    s_cmp_eq_u32 s57, 2
    s_cbranch_scc1 L_H_2
    s_cmp_eq_u32 s57, 3
    s_cbranch_scc1 L_H_3
    s_branch L_safe
L_wrap1:
    s_setprio 2
L_wrap1b:
    v_lshrrev_b32 v37, 4, v0
    v_lshlrev_b32 v38, 2, v37
    v_and_b32 v39, 15, v0
    v_xor_b32 v38, v38, v39
    v_lshlrev_b32 v38, 4, v38
    v_lshl_add_u32 v38, v37, 8, v38
    s_mov_b32 s58, 0
L_spin_13:
    ds_read_b32 v43, v42 offset:20
    s_add_u32 s58, s58, 1
    s_waitcnt lgkmcnt(0)
    v_readfirstlane_b32 s60, v43
    s_cmp_ge_u32 s60, 16
    s_cbranch_scc1 L_qrd
    s_sleep 1
    s_cmp_lt_u32 s58, 1048576
    s_cbranch_scc1 L_spin_13
L_qrd:
    s_lshl_b32 s58, s3, 12
    s_add_u32 m0, s58, 4096
    s_nop 0
    buffer_load_dwordx4 v38, s[28:31], s58 offen offset:0 lds
    buffer_load_dwordx4 v38, s[28:31], s58 offen offset:1024 lds
    buffer_load_dwordx4 v38, s[28:31], s58 offen offset:2048 lds
    buffer_load_dwordx4 v38, s[28:31], s58 offen offset:3072 lds
    s_cmp_eq_u32 s57, 0
    s_cbranch_scc1 L_E0_0
    s_cmp_eq_u32 s57, 1
    s_cbranch_scc1 L_E0_1
    s_cmp_eq_u32 s57, 2
    s_cbranch_scc1 L_E0_2
    s_cmp_eq_u32 s57, 3
    s_cbranch_scc1 L_E0_3
    s_branch L_hk1
L_rs0:
    v_readfirstlane_b32 s58, v1
    s_add_u32 s58, s58, 768
    s_mov_b32 exec_lo, 0
    v_mov_b32 v1, s58
    s_mov_b32 exec_lo, -1
    ds_read_b128 v[16:19], v1 offset:32
    ds_read_b128 v[20:23], v1 offset:48
    s_mov_b32 s81, 0
    ds_read2_b32 v[36:37], v1 offset0:0 offset1:2
    ds_read2_b32 v[38:39], v1 offset0:4 offset1:6
    s_waitcnt lgkmcnt(0)
    buffer_load_dwordx4 v[24:27], v36, s[40:43], s70 offen sc1
    buffer_load_dwordx4 v[28:31], v37, s[40:43], s70 offen sc1
    buffer_load_dwordx4 v[44:47], v38, s[40:43], s70 offen sc1
    buffer_load_dwordx4 v[48:51], v39, s[40:43], s70 offen sc1
    s_branch L_flush
L_rs1:
    v_readfirstlane_b32 s58, v1
    s_add_u32 s58, s58, 768
    s_mov_b32 exec_lo, 0
    v_mov_b32 v1, s58
    s_mov_b32 exec_lo, -1
    ds_read_b128 v[16:19], v1 offset:32
    ds_read_b128 v[20:23], v1 offset:48
    s_mov_b32 s81, 1
    ds_read2_b32 v[36:37], v1 offset0:2 offset1:4
    ds_read2_b32 v[38:39], v1 offset0:6 offset1:8
    s_waitcnt lgkmcnt(0)
    buffer_load_dwordx4 v[28:31], v36, s[40:43], s70 offen sc1
    buffer_load_dwordx4 v[44:47], v37, s[40:43], s70 offen sc1
    buffer_load_dwordx4 v[48:51], v38, s[40:43], s70 offen sc1
    buffer_load_dwordx4 v[24:27], v39, s[40:43], s70 offen sc1
    s_branch L_flush
L_rs2:
    v_readfirstlane_b32 s58, v1
    s_add_u32 s58, s58, 768
    s_mov_b32 exec_lo, 0
    v_mov_b32 v1, s58
    s_mov_b32 exec_lo, -1
    ds_read_b128 v[16:19], v1 offset:64
    ds_read_b128 v[20:23], v1 offset:48
    s_mov_b32 s81, 2
    ds_read2_b32 v[36:37], v1 offset0:4 offset1:6
    ds_read2_b32 v[38:39], v1 offset0:8 offset1:10
    s_waitcnt lgkmcnt(0)
    buffer_load_dwordx4 v[44:47], v36, s[40:43], s70 offen sc1
    buffer_load_dwordx4 v[48:51], v37, s[40:43], s70 offen sc1
    buffer_load_dwordx4 v[24:27], v38, s[40:43], s70 offen sc1
    buffer_load_dwordx4 v[28:31], v39, s[40:43], s70 offen sc1
    s_branch L_flush
L_rs3:
    v_readfirstlane_b32 s58, v1
    s_add_u32 s58, s58, 768
    s_mov_b32 exec_lo, 0
    v_mov_b32 v1, s58
    s_mov_b32 exec_lo, -1
    ds_read_b128 v[16:19], v1 offset:64
    ds_read_b128 v[20:23], v1 offset:48
    s_mov_b32 s81, 3
    ds_read2_b32 v[36:37], v1 offset0:6 offset1:8
    ds_read2_b32 v[38:39], v1 offset0:10 offset1:12
    s_waitcnt lgkmcnt(0)
    buffer_load_dwordx4 v[48:51], v36, s[40:43], s70 offen sc1
    buffer_load_dwordx4 v[24:27], v37, s[40:43], s70 offen sc1
    buffer_load_dwordx4 v[28:31], v38, s[40:43], s70 offen sc1
    buffer_load_dwordx4 v[44:47], v39, s[40:43], s70 offen sc1
L_flush:
    s_waitcnt lgkmcnt(0)
    v_lshrrev_b32 v36, 5, v0
    v_add_u32 v36, s80, v36
    v_mul_u32_u24 v36, 528, v36
    v_bfe_u32 v37, v0, 2, 3
    v_lshl_add_u32 v36, v37, 6, v36
    v_and_b32 v37, 3, v0
    v_lshl_add_u32 v36, v37, 3, v36
    v_add_u32 v36, 69632, v36
    s_cmp_lg_u32 s83, 0
    s_cbranch_scc1 L_flush2
    v_pk_mul_f32 v[32:33], v[60:61], v[64:65]
    v_pk_mul_f32 v[34:35], v[62:63], v[66:67]
    v_pk_fma_f32 v[32:33], v[72:73], v[76:77], v[32:33]
    v_pk_fma_f32 v[34:35], v[74:75], v[78:79], v[34:35]
    v_pk_fma_f32 v[32:33], v[84:85], v[88:89], v[32:33]
    v_pk_fma_f32 v[34:35], v[86:87], v[90:91], v[34:35]
    v_pk_fma_f32 v[32:33], v[96:97], v[100:101], v[32:33]
    v_pk_fma_f32 v[34:35], v[98:99], v[102:103], v[34:35]
    v_pk_fma_f32 v[32:33], v[108:109], v[112:113], v[32:33]
    v_pk_fma_f32 v[34:35], v[110:111], v[114:115], v[34:35]
    v_pk_fma_f32 v[32:33], v[120:121], v[124:125], v[32:33]
    v_pk_fma_f32 v[34:35], v[122:123], v[126:127], v[34:35]
    v_pk_add_f32 v[32:33], v[32:33], v[34:35]
    v_add_f32 v32, v32, v33
    v_mov_b32 v33, 0x207
    v_cmp_class_f32 vcc, v32, v33
    s_cmp_lg_u32 s55, 0
    s_cbranch_scc1 L_fl2
    s_cbranch_vccnz L_safe
L_fl2:
    v_rcp_f32 v64, v64
    v_rcp_f32 v65, v65
    v_rcp_f32 v66, v66
    v_rcp_f32 v67, v67
    v_pk_mul_f32 v[60:61], v[60:61], v[64:65]
    v_pk_mul_f32 v[62:63], v[62:63], v[66:67]
    v_cvt_pk_bf16_f32 v8, v60, v61
    v_cvt_pk_bf16_f32 v9, v62, v63
    ds_write_b64 v36, v[8:9] offset:0
    v_rcp_f32 v76, v76
    v_rcp_f32 v77, v77
    v_rcp_f32 v78, v78
    v_rcp_f32 v79, v79
    v_pk_mul_f32 v[72:73], v[72:73], v[76:77]
    v_pk_mul_f32 v[74:75], v[74:75], v[78:79]
    v_cvt_pk_bf16_f32 v10, v72, v73
    v_cvt_pk_bf16_f32 v11, v74, v75
    ds_write_b64 v36, v[10:11] offset:32
    v_rcp_f32 v88, v88
    v_rcp_f32 v89, v89
    v_rcp_f32 v90, v90
    v_rcp_f32 v91, v91
    v_pk_mul_f32 v[84:85], v[84:85], v[88:89]
    v_pk_mul_f32 v[86:87], v[86:87], v[90:91]
    v_cvt_pk_bf16_f32 v8, v84, v85
    v_cvt_pk_bf16_f32 v9, v86, v87
    ds_write_b64 v36, v[8:9] offset:1056
    v_rcp_f32 v100, v100
    v_rcp_f32 v101, v101
    v_rcp_f32 v102, v102
    v_rcp_f32 v103, v103
    v_pk_mul_f32 v[96:97], v[96:97], v[100:101]
    v_pk_mul_f32 v[98:99], v[98:99], v[102:103]
    v_cvt_pk_bf16_f32 v10, v96, v97
    v_cvt_pk_bf16_f32 v11, v98, v99
    ds_write_b64 v36, v[10:11] offset:1088
    v_rcp_f32 v112, v112
    v_rcp_f32 v113, v113
    v_rcp_f32 v114, v114
    v_rcp_f32 v115, v115
    v_pk_mul_f32 v[108:109], v[108:109], v[112:113]
    v_pk_mul_f32 v[110:111], v[110:111], v[114:115]
    v_cvt_pk_bf16_f32 v8, v108, v109
    v_cvt_pk_bf16_f32 v9, v110, v111
    ds_write_b64 v36, v[8:9] offset:2112
L_stub14:
    s_cbranch_execz L_Bback
    v_rcp_f32 v124, v124
    v_rcp_f32 v125, v125
    v_rcp_f32 v126, v126
    v_rcp_f32 v127, v127
    v_pk_mul_f32 v[120:121], v[120:121], v[124:125]
    v_pk_mul_f32 v[122:123], v[122:123], v[126:127]
    v_cvt_pk_bf16_f32 v10, v120, v121
    v_cvt_pk_bf16_f32 v11, v122, v123
    ds_write_b64 v36, v[10:11] offset:2144
    s_cmp_lg_u32 s3, 0
    s_cbranch_scc1 L_fl3
    s_mov_b32 s58, 161792
    v_lshl_add_u32 v37, v0, 4, s58
    ds_read_b128 v[56:59], v37
    ds_read_b128 v[68:71], v37 offset:1024
    s_mov_b32 s60, 1.0
    s_mov_b32 s61, 1.0
    s_mov_b32 s83, 1
    v_mov_b64 v[60:61], 0
    v_mov_b64 v[62:63], 0
    v_mov_b64 v[64:65], s[60:61]
    v_mov_b64 v[66:67], s[60:61]
    v_mov_b64 v[72:73], 0
    v_mov_b64 v[74:75], 0
    v_mov_b64 v[76:77], s[60:61]
    v_mov_b64 v[78:79], s[60:61]
    s_waitcnt lgkmcnt(0)
    s_cmp_lg_u32 s55, 0
    s_cbranch_scc1 L_safe
    s_cmp_eq_u32 s81, 0
    s_cbranch_scc1 L_E0_0
    s_cmp_eq_u32 s81, 1
    s_cbranch_scc1 L_E0_1
    s_cmp_eq_u32 s81, 2
    s_cbranch_scc1 L_E0_2
    s_branch L_E0_3
L_flush2:
    v_pk_mul_f32 v[32:33], v[60:61], v[64:65]
    v_pk_mul_f32 v[34:35], v[62:63], v[66:67]
    v_pk_fma_f32 v[32:33], v[72:73], v[76:77], v[32:33]
    v_pk_fma_f32 v[34:35], v[74:75], v[78:79], v[34:35]
    v_pk_add_f32 v[32:33], v[32:33], v[34:35]
    v_add_f32 v32, v32, v33
    v_mov_b32 v33, 0x207
    v_cmp_class_f32 vcc, v32, v33
    s_cmp_lg_u32 s55, 0
    s_cbranch_scc1 L_fl2b
    s_cbranch_vccnz L_safe
L_fl2b:
    v_rcp_f32 v64, v64
    v_rcp_f32 v65, v65
    v_rcp_f32 v66, v66
    v_rcp_f32 v67, v67
    v_pk_mul_f32 v[60:61], v[60:61], v[64:65]
    v_pk_mul_f32 v[62:63], v[62:63], v[66:67]
    v_cvt_pk_bf16_f32 v8, v60, v61
    v_cvt_pk_bf16_f32 v9, v62, v63
    ds_write_b64 v36, v[8:9] offset:3168
    v_rcp_f32 v76, v76
    v_rcp_f32 v77, v77
    v_rcp_f32 v78, v78
    v_rcp_f32 v79, v79
    v_pk_mul_f32 v[72:73], v[72:73], v[76:77]
    v_pk_mul_f32 v[74:75], v[74:75], v[78:79]
    v_cvt_pk_bf16_f32 v10, v72, v73
    v_cvt_pk_bf16_f32 v11, v74, v75
    ds_write_b64 v36, v[10:11] offset:3200
L_fl3:
    s_and_b32 s60, s3, 3
    s_lshr_b32 s61, s3, 2
    s_lshl_b32 s59, s61, 2
    v_mov_b32 v2, s59
    v_mov_b32 v3, 1
    s_waitcnt lgkmcnt(0)
    s_mov_b64 exec, 1
    ds_add_u32 v2, v3 offset:192
    s_mov_b64 exec, -1
    v_lshrrev_b32 v4, 4, v0
    v_and_b32 v5, 15, v0
    s_lshl_b32 s56, s60, 6
    v_lshl_add_u32 v6, v4, 4, s56
    global_load_dwordx4 v[124:127], v6, s[18:19]
    v_bfe_u32 v7, v0, 2, 2
    v_lshl_add_u32 v1, v4, 3, v7
    v_lshlrev_b32 v1, 8, v1
    v_xor_b32 v7, s60, v7
    v_lshl_add_u32 v1, v7, 6, v1
    v_and_b32 v7, 3, v0
    v_lshl_add_u32 v1, v7, 4, v1
    s_mov_b32 s58, 0
L_spin_14:
    ds_read_b32 v43, v42 offset:16
    s_add_u32 s58, s58, 1
    s_waitcnt lgkmcnt(0)
    v_readfirstlane_b32 s57, v43
    s_cmp_ge_u32 s57, 16
    s_cbranch_scc1 L_w2ok
    s_sleep 1
    s_cmp_lt_u32 s58, 1048576
    s_cbranch_scc1 L_spin_14
L_w2ok:
    s_waitcnt vmcnt(1)
    ds_read_b64_tr_b16 v[44:45], v1 offset:4096
    ds_read_b64_tr_b16 v[46:47], v1 offset:5120
    ds_read_b64_tr_b16 v[76:77], v1 offset:4104
    ds_read_b64_tr_b16 v[78:79], v1 offset:5128
    ds_read_b64_tr_b16 v[48:49], v1 offset:12288
    ds_read_b64_tr_b16 v[50:51], v1 offset:13312
    ds_read_b64_tr_b16 v[80:81], v1 offset:12296
    ds_read_b64_tr_b16 v[82:83], v1 offset:13320
    ds_read_b64_tr_b16 v[52:53], v1 offset:20480
    ds_read_b64_tr_b16 v[54:55], v1 offset:21504
    ds_read_b64_tr_b16 v[84:85], v1 offset:20488
    ds_read_b64_tr_b16 v[86:87], v1 offset:21512
    ds_read_b64_tr_b16 v[56:57], v1 offset:28672
    ds_read_b64_tr_b16 v[58:59], v1 offset:29696
    ds_read_b64_tr_b16 v[88:89], v1 offset:28680
    ds_read_b64_tr_b16 v[90:91], v1 offset:29704
    ds_read_b64_tr_b16 v[60:61], v1 offset:36864
    ds_read_b64_tr_b16 v[62:63], v1 offset:37888
    ds_read_b64_tr_b16 v[92:93], v1 offset:36872
    ds_read_b64_tr_b16 v[94:95], v1 offset:37896
    ds_read_b64_tr_b16 v[64:65], v1 offset:45056
    ds_read_b64_tr_b16 v[66:67], v1 offset:46080
    ds_read_b64_tr_b16 v[96:97], v1 offset:45064
    ds_read_b64_tr_b16 v[98:99], v1 offset:46088
    ds_read_b64_tr_b16 v[68:69], v1 offset:53248
    ds_read_b64_tr_b16 v[70:71], v1 offset:54272
    ds_read_b64_tr_b16 v[100:101], v1 offset:53256
    ds_read_b64_tr_b16 v[102:103], v1 offset:54280
    ds_read_b64_tr_b16 v[72:73], v1 offset:61440
    ds_read_b64_tr_b16 v[74:75], v1 offset:62464
    ds_read_b64_tr_b16 v[104:105], v1 offset:61448
    ds_read_b64_tr_b16 v[106:107], v1 offset:62472
    s_mul_i32 s56, s61, 24
    s_min_u32 s57, s61, 1
    s_lshl1_add_u32 s56, s57, s56
    v_add_u32 v5, s56, v5
    v_lshlrev_b32 v3, 2, v5
    v_mul_u32_u24 v1, 528, v5
    v_lshl_add_u32 v1, v4, 4, v1
    v_add_u32 v1, 69632, v1
    s_mov_b32 s32, s20
    s_mov_b32 s33, s21
    s_add_u32 s34, s51, s52
    s_lshl_b32 s34, s34, 8
    s_mov_b32 s35, 0x00020000
    s_add_u32 s59, s51, 127
    s_lshl_b32 s59, s59, 8
    v_add_u32 v6, s59, v6
    s_cmp_eq_u32 s61, 0
    s_mov_b32 s96, 0x00ff00ff
    s_cselect_b32 s96, 0x03ff03ff, s96
    s_mov_b32 s97, s96
    s_movk_i32 s59, -256
    s_mov_b32 s56, 0xbf317218
    s_mov_b32 s58, 0
L_spin_15:
    ds_read_b32 v43, v2 offset:192
    s_add_u32 s58, s58, 1
    s_waitcnt lgkmcnt(0)
    v_readfirstlane_b32 s57, v43
    s_cmp_ge_u32 s57, 4
    s_cbranch_scc1 L_gok
    s_sleep 1
    s_cmp_lt_u32 s58, 1048576
    s_cbranch_scc1 L_spin_15
L_gok:
    ds_read_b32 v42, v3 offset:1280
    ds_read_b32 v43, v3 offset:1344
    ds_read_b128 v[108:111], v1 offset:0
    ds_read_b128 v[112:115], v1 offset:64
    ds_read_b128 v[116:119], v1 offset:8448
    ds_read_b128 v[120:123], v1 offset:8512
    ds_read_b128 v[8:11], v1 offset:128
    ds_read_b128 v[12:15], v1 offset:192
    ds_read_b128 v[16:19], v1 offset:8576
    ds_read_b128 v[20:23], v1 offset:8640
    s_waitcnt lgkmcnt(4)
    v_mfma_f32_16x16x32_bf16 v[24:27], v[44:47], v[108:111], 0
    v_mfma_f32_16x16x32_bf16 v[28:31], v[76:79], v[108:111], 0
    v_mfma_f32_16x16x32_bf16 v[32:35], v[44:47], v[116:119], 0
    v_mfma_f32_16x16x32_bf16 v[36:39], v[76:79], v[116:119], 0
    v_mfma_f32_16x16x32_bf16 v[24:27], v[48:51], v[112:115], v[24:27]
    v_mfma_f32_16x16x32_bf16 v[28:31], v[80:83], v[112:115], v[28:31]
    v_mfma_f32_16x16x32_bf16 v[32:35], v[48:51], v[120:123], v[32:35]
    v_mfma_f32_16x16x32_bf16 v[36:39], v[80:83], v[120:123], v[36:39]
    v_and_b32 v4, 127, v42
    v_lshrrev_b32 v42, 8, v42
    v_mad_i32_i24 v4, v4, s59, v6
    v_cvt_f32_u32 v42, v42
    v_and_b32 v5, 127, v43
    v_lshrrev_b32 v43, 8, v43
    v_mad_i32_i24 v5, v5, s59, v6
    v_cvt_f32_u32 v43, v43
L_stub15:
    s_cbranch_execz L_Bback
    ds_read_b128 v[108:111], v1 offset:256
    ds_read_b128 v[112:115], v1 offset:320
    ds_read_b128 v[116:119], v1 offset:8704
    ds_read_b128 v[120:123], v1 offset:8768
    s_waitcnt lgkmcnt(4)
    v_mfma_f32_16x16x32_bf16 v[24:27], v[52:55], v[8:11], v[24:27]
    v_mfma_f32_16x16x32_bf16 v[28:31], v[84:87], v[8:11], v[28:31]
    v_mfma_f32_16x16x32_bf16 v[32:35], v[52:55], v[16:19], v[32:35]
    v_mfma_f32_16x16x32_bf16 v[36:39], v[84:87], v[16:19], v[36:39]
    v_mfma_f32_16x16x32_bf16 v[24:27], v[56:59], v[12:15], v[24:27]
    v_mfma_f32_16x16x32_bf16 v[28:31], v[88:91], v[12:15], v[28:31]
    v_mfma_f32_16x16x32_bf16 v[32:35], v[56:59], v[20:23], v[32:35]
    v_mfma_f32_16x16x32_bf16 v[36:39], v[88:91], v[20:23], v[36:39]
    ds_read_b128 v[8:11], v1 offset:384
    ds_read_b128 v[12:15], v1 offset:448
    ds_read_b128 v[16:19], v1 offset:8832
    ds_read_b128 v[20:23], v1 offset:8896
    s_waitcnt lgkmcnt(4)
    v_mfma_f32_16x16x32_bf16 v[24:27], v[60:63], v[108:111], v[24:27]
    v_mfma_f32_16x16x32_bf16 v[28:31], v[92:95], v[108:111], v[28:31]
    v_mfma_f32_16x16x32_bf16 v[32:35], v[60:63], v[116:119], v[32:35]
    v_mfma_f32_16x16x32_bf16 v[36:39], v[92:95], v[116:119], v[36:39]
    v_mfma_f32_16x16x32_bf16 v[24:27], v[64:67], v[112:115], v[24:27]
    v_mfma_f32_16x16x32_bf16 v[28:31], v[96:99], v[112:115], v[28:31]
    v_mfma_f32_16x16x32_bf16 v[32:35], v[64:67], v[120:123], v[32:35]
    v_mfma_f32_16x16x32_bf16 v[36:39], v[96:99], v[120:123], v[36:39]
    s_waitcnt lgkmcnt(0)
    v_mfma_f32_16x16x32_bf16 v[24:27], v[68:71], v[8:11], v[24:27]
    v_mfma_f32_16x16x32_bf16 v[28:31], v[100:103], v[8:11], v[28:31]
    v_mfma_f32_16x16x32_bf16 v[32:35], v[68:71], v[16:19], v[32:35]
    v_mfma_f32_16x16x32_bf16 v[36:39], v[100:103], v[16:19], v[36:39]
    v_mfma_f32_16x16x32_bf16 v[24:27], v[72:75], v[12:15], v[24:27]
    v_mfma_f32_16x16x32_bf16 v[28:31], v[104:107], v[12:15], v[28:31]
    v_mfma_f32_16x16x32_bf16 v[32:35], v[72:75], v[20:23], v[32:35]
    v_mfma_f32_16x16x32_bf16 v[36:39], v[104:107], v[20:23], v[36:39]
    s_waitcnt vmcnt(0)
    v_lshlrev_b32 v44, 16, v124
    v_and_b32 v45, s26, v124
    v_lshlrev_b32 v46, 16, v125
    v_and_b32 v47, s26, v125
    v_lshlrev_b32 v48, 16, v126
    v_and_b32 v49, s26, v126
    v_lshlrev_b32 v50, 16, v127
    v_and_b32 v51, s26, v127
    v_mul_f32 v52, v42, v44
    v_mul_f32 v53, v42, v45
    v_mul_f32 v54, v42, v46
    v_mul_f32 v55, v42, v47
    v_mul_f32 v56, v42, v48
    v_mul_f32 v57, v42, v49
    v_mul_f32 v58, v42, v50
    v_mul_f32 v59, v42, v51
    v_mul_f32 v60, v43, v44
    v_mul_f32 v61, v43, v45
    v_mul_f32 v62, v43, v46
    v_mul_f32 v63, v43, v47
    v_mul_f32 v64, v43, v48
    v_mul_f32 v65, v43, v49
    v_mul_f32 v66, v43, v50
    v_mul_f32 v67, v43, v51
    v_fma_f32 v24, v24, s56, v52
    v_fma_f32 v25, v25, s56, v53
    v_fma_f32 v26, v26, s56, v54
    v_fma_f32 v27, v27, s56, v55
    v_fma_f32 v28, v28, s56, v56
    v_fma_f32 v29, v29, s56, v57
    v_fma_f32 v30, v30, s56, v58
    v_fma_f32 v31, v31, s56, v59
    v_cvt_pk_bf16_f32 v68, v24, v25
    v_cvt_pk_bf16_f32 v69, v26, v27
    v_cvt_pk_bf16_f32 v70, v28, v29
    v_cvt_pk_bf16_f32 v71, v30, v31
    buffer_store_dwordx4 v[68:71], v4, s[32:35], 0 offen
    v_fma_f32 v32, v32, s56, v60
    v_fma_f32 v33, v33, s56, v61
    v_fma_f32 v34, v34, s56, v62
    v_fma_f32 v35, v35, s56, v63
    v_fma_f32 v36, v36, s56, v64
    v_fma_f32 v37, v37, s56, v65
    v_fma_f32 v38, v38, s56, v66
    v_fma_f32 v39, v39, s56, v67
    v_cvt_pk_bf16_f32 v72, v32, v33
    v_cvt_pk_bf16_f32 v73, v34, v35
    v_cvt_pk_bf16_f32 v74, v36, v37
    v_cvt_pk_bf16_f32 v75, v38, v39
    s_mov_b64 exec, s[96:97]
    buffer_store_dwordx4 v[72:75], v5, s[32:35], 0 offen
L_fin:
L_end:
    s_endpgm
L_fill2:
    v_readlane_b32 s61, v10, 63
    v_add_u32 v9, 64, v0
    v_min_u32 v9, s56, v9
    v_lshl_add_u32 v9, v9, 2, s57
    v_add_u32 v13, 512, v13
    v_max_u32 v11, s61, v11
    s_nop 1
    v_max_u32_dpp v11, v11, v11 row_shr:1 row_mask:0xf bank_mask:0xf bound_ctrl:0
    s_nop 1
    v_max_u32_dpp v11, v11, v11 row_shr:2 row_mask:0xf bank_mask:0xf bound_ctrl:0
    s_nop 1
    v_max_u32_dpp v11, v11, v11 row_shr:4 row_mask:0xf bank_mask:0xf bound_ctrl:0
    s_nop 1
    v_max_u32_dpp v11, v11, v11 row_shr:8 row_mask:0xf bank_mask:0xf bound_ctrl:0
    s_nop 1
    v_max_u32_dpp v11, v11, v11 row_bcast:15 row_mask:0xa bank_mask:0xf
    s_nop 1
    v_max_u32_dpp v11, v11, v11 row_bcast:31 row_mask:0xc bank_mask:0xf
    s_mov_b64 exec, 0xffffffff
    v_and_b32 v14, 0x1fff, v11
    v_bfe_u32 v15, v11, 13, 13
    v_lshl_add_u32 v14, v14, 2, v9
    v_lshl_add_u32 v15, v15, 2, v9
    ds_read_b32 v14, v14
    ds_read_b32 v15, v15
    s_waitcnt lgkmcnt(1)
    v_and_b32 v16, 0x7fff, v14
    v_mad_u32_u24 v16, v16, s60, s60
    v_and_b32 v14, s26, v14
    ds_write2_b32 v13, v16, v14 offset0:0 offset1:9
    s_waitcnt lgkmcnt(1)
    v_and_b32 v17, 0x7fff, v15
    v_lshlrev_b32 v17, 9, v17
    v_and_b32 v15, s26, v15
    ds_write2_b32 v13, v17, v15 offset0:192 offset1:201
    s_mov_b64 exec, -1
    s_branch L_filled
L_recover:
    s_setprio 0
    s_waitcnt vmcnt(0) lgkmcnt(0)
    s_barrier
    s_mov_b32 s54, 0
L_recov_step:
    s_add_u32 s54, s54, 1
    s_add_u32 s48, s2, s54
    s_and_b32 s48, s48, 255
    s_and_b32 s56, s48, 7
    s_lshl_b32 s56, s56, 5
    s_lshr_b32 s27, s48, 3
    s_or_b32 s56, s56, s27
    s_mul_i32 s49, s56, 6400845
    s_add_u32 s49, s49, 65535
    s_add_u32 s50, s49, 6400845
    s_lshr_b32 s49, s49, 16
    s_lshr_b32 s50, s50, 16
    s_min_u32 s50, s50, 25000
    s_cmp_lt_u32 s3, 8
    s_cbranch_scc1 L_Gfirst
L_recovL:
    s_barrier
L_recovG:
    s_waitcnt vmcnt(0) lgkmcnt(0)
    s_barrier
    s_cmp_lt_u32 s54, 256
    s_cbranch_scc1 L_recov_step
    v_mov_b32 v43, 1
    ds_write_b32 v42, v43 offset:12
    ds_write_b32 v42, v43 offset:28
    v_mov_b32 v43, 0
    ds_write_b32 v42, v43 offset:16
    ds_write_b32 v42, v43 offset:20
    s_mov_b32 s22, 0
    s_cmp_eq_u32 s3, 0
    s_cselect_b32 s22, 0x302e221c, s22
    s_cmp_eq_u32 s3, 1
    s_cselect_b32 s22, 0x2d1d01, s22
    s_cmp_eq_u32 s3, 2
    s_cselect_b32 s22, 0x25130a, s22
    s_cmp_eq_u32 s3, 3
    s_cselect_b32 s22, 0x2a1803, s22
    s_cmp_eq_u32 s3, 4
    s_cselect_b32 s22, 0x2f2700, s22
    s_cmp_eq_u32 s3, 5
    s_cselect_b32 s22, 0x201909, s22
    s_cmp_eq_u32 s3, 6
    s_cselect_b32 s22, 0x2c1702, s22
    s_cmp_eq_u32 s3, 7
    s_cselect_b32 s22, 0x2b1404, s22
    s_cmp_eq_u32 s3, 8
    s_cselect_b32 s22, 0x1e1a08, s22
    s_cmp_eq_u32 s3, 9
    s_cselect_b32 s22, 0x281506, s22
    s_cmp_eq_u32 s3, 10
    s_cselect_b32 s22, 0x211f05, s22
    s_cmp_eq_u32 s3, 11
    s_cselect_b32 s22, 0x26120b, s22
    s_cmp_eq_u32 s3, 12
    s_cselect_b32 s22, 0x240f0c, s22
    s_cmp_eq_u32 s3, 13
    s_cselect_b32 s22, 0x291007, s22
    s_cmp_eq_u32 s3, 14
    s_cselect_b32 s22, 0x23110d, s22
    s_cmp_eq_u32 s3, 15
    s_cselect_b32 s22, 0x1b160e, s22
    v_mul_u32_u24 v33, 43, v0
    v_lshrrev_b32 v33, 7, v33
    v_mul_u32_u24 v34, 24, v33
    v_lshlrev_b32 v32, 3, v0
    v_sub_u32 v32, v32, v34
    v_cmp_lt_u32 vcc, 14, v0
    s_nop 1
    v_cndmask_b32 v32, v32, 24, vcc
    v_bfe_u32 v32, s22, v32, 8
    v_lshlrev_b32 v32, 3, v32
    v_mad_u32_u24 v33, v33, 6, 8
    v_subrev_u32 v34, 6, v33
    v_min_u32 v33, 26, v33
    v_min_u32 v34, 26, v34
    s_mov_b32 s56, 48912210
    v_lshl_add_u32 v35, v0, 26, s56
    v_lshrrev_b32 v43, 5, v0
    s_bfe_u32 s56, s22, 0x80000
    s_bfe_u32 s57, s22, 0x80008
    s_bfe_u32 s58, s22, 0x80010
    s_lshl_b32 s56, s56, 3
    s_lshl_b32 s57, s57, 3
    s_lshl_b32 s58, s58, 3
    v_lshl_add_u32 v36, v43, 2, s56
    v_lshl_add_u32 v37, v43, 2, s57
    v_lshl_add_u32 v38, v43, 2, s58
    v_bfe_u32 v43, v0, 2, 3
    v_mul_u32_u24 v39, 14336, v43
    v_and_b32 v43, 3, v0
    v_lshl_add_u32 v39, v43, 5, v39
    v_and_b32 v43, 4, v0
    v_lshl_add_u32 v39, v43, 2, v39
    v_and_b32 v43, 8, v0
    v_lshl_add_u32 v39, v43, 4, v39
    v_add_u32 v39, 22384, v39
    s_lshl_b32 s56, s3, 6
    v_and_b32 v40, 60, v0
    v_add_u32 v40, s56, v40
    s_waitcnt lgkmcnt(0)
    s_barrier
    s_branch L_B4
L_safe0:
    s_mov_b32 s57, 4
    s_branch L_wrap1b
L_safe:
    s_mov_b32 s55, 1
    s_setprio 0
    s_mov_b32 s60, 1.0
    s_mov_b32 s61, 1.0
    s_mul_i32 s73, s83, 6
    s_add_u32 s73, s73, s80
    s_lshl_b32 s73, s73, 2
    v_lshl_add_u32 v23, v0, 2, s73
    s_waitcnt vmcnt(0) lgkmcnt(0)
    ds_read_b32 v22, v23 offset:1280
    v_mov_b64 v[60:61], 0
    v_mov_b64 v[62:63], 0
    v_mov_b64 v[64:65], s[60:61]
    v_mov_b64 v[66:67], s[60:61]
    v_mov_b64 v[72:73], 0
    v_mov_b64 v[74:75], 0
    v_mov_b64 v[76:77], s[60:61]
    v_mov_b64 v[78:79], s[60:61]
    v_mov_b64 v[84:85], 0
    v_mov_b64 v[86:87], 0
    v_mov_b64 v[88:89], s[60:61]
    v_mov_b64 v[90:91], s[60:61]
    v_mov_b64 v[96:97], 0
    v_mov_b64 v[98:99], 0
    v_mov_b64 v[100:101], s[60:61]
    v_mov_b64 v[102:103], s[60:61]
    v_mov_b64 v[108:109], 0
    v_mov_b64 v[110:111], 0
    v_mov_b64 v[112:113], s[60:61]
    v_mov_b64 v[114:115], s[60:61]
    v_mov_b64 v[120:121], 0
    v_mov_b64 v[122:123], 0
    v_mov_b64 v[124:125], s[60:61]
    v_mov_b64 v[126:127], s[60:61]
    s_mov_b32 s28, s10
    s_mov_b32 s29, s11
    s_mov_b32 s30, 1600000
    s_mov_b32 s31, 0x00020000
    s_mov_b32 s32, s8
    s_mov_b32 s33, s9
    s_mov_b32 s34, 1600000
    s_mov_b32 s35, 0x00020000
    s_mov_b32 s36, s6
    s_mov_b32 s37, s7
    s_mov_b32 s38, 800000
    s_mov_b32 s39, 0x00020000
    v_lshlrev_b32 v16, 2, v0
    v_lshlrev_b32 v17, 1, v0
    v_and_b32 v24, 31, v0
    v_lshlrev_b32 v24, 4, v24
    s_mov_b32 s72, 0
    s_movk_i32 s74, 24999
    s_waitcnt lgkmcnt(0)
    v_and_b32 v22, 127, v22
    v_sub_u32 v25, 127, v22
    s_nop 0
    v_readlane_b32 s64, v25, 0
    v_readlane_b32 s65, v25, 1
    v_readlane_b32 s66, v25, 2
    v_readlane_b32 s67, v25, 3
    v_readlane_b32 s68, v25, 4
    v_readlane_b32 s69, v25, 5
    s_cmp_eq_u32 s83, 0
    s_cbranch_scc1 L_sloop
    s_mov_b32 s66, -1
    s_mov_b32 s67, -1
    s_mov_b32 s68, -1
    s_mov_b32 s69, -1
L_sloop:
    s_lshl_b32 s56, s72, 1
    buffer_load_dword v18, v16, s[28:31], s56 offen
    buffer_load_dword v19, v16, s[32:35], s56 offen
    buffer_load_ushort v20, v17, s[36:39], s72 offen
    s_waitcnt vmcnt(0)
    v_min_u32 v18, s74, v18
    v_subrev_u32 v21, s51, v18
    v_cmp_gt_u32 s[96:97], s52, v21
    s_cmp_eq_u64 s[96:97], 0
    s_cbranch_scc1 L_snext
    v_mov_b32 v25, 6
    v_cmp_eq_u32 vcc, s64, v21
    s_nop 1
    v_cndmask_b32 v25, v25, 0, vcc
    v_cmp_eq_u32 vcc, s65, v21
    s_nop 1
    v_cndmask_b32 v25, v25, 1, vcc
    v_cmp_eq_u32 vcc, s66, v21
    s_nop 1
    v_cndmask_b32 v25, v25, 2, vcc
    v_cmp_eq_u32 vcc, s67, v21
    s_nop 1
    v_cndmask_b32 v25, v25, 3, vcc
    v_cmp_eq_u32 vcc, s68, v21
    s_nop 1
    v_cndmask_b32 v25, v25, 4, vcc
    v_cmp_eq_u32 vcc, s69, v21
    s_nop 1
    v_cndmask_b32 v25, v25, 5, vcc
    v_cmp_gt_u32 vcc, 6, v25
    s_and_b64 s[96:97], s[96:97], vcc
L_sbit:
    s_mov_b64 exec, -1
    s_cmp_eq_u64 s[96:97], 0
    s_cbranch_scc1 L_snext
    s_ff1_i32_b64 s56, s[96:97]
    s_bitset0_b64 s[96:97], s56
    v_readlane_b32 s57, v19, s56
    v_readlane_b32 s58, v20, s56
    v_readlane_b32 s60, v25, s56
    s_min_u32 s57, s57, s74
    s_lshl_b32 s57, s57, 9
    s_add_u32 s57, s57, 249561600
    s_lshl_b32 s58, s58, 16
    s_mov_b32 s59, s58
    buffer_load_dwordx4 v[28:31], v24, s[44:47], s57 offen sc1
    s_lshl_b64 exec, 1, s60
    v_add_u32 v22, 0x100, v22
    s_bitcmp1_b32 s60, 0
    s_cselect_b32 exec_lo, 0, -1
    s_cselect_b32 exec_hi, -1, 0
    s_lshr_b32 s60, s60, 1
    s_waitcnt vmcnt(0)
    s_cmp_lg_u32 s60, 0
    s_cbranch_scc1 L_sk1
    v_pk_fma_f32 v[8:9], s[58:59], v[4:5], v[56:57]
    v_pk_fma_f32 v[10:11], s[58:59], v[6:7], v[58:59]
    s_nop 1
    v_mfma_f32_4x4x4_16b_bf16 v[8:11], v[2:3], v[28:29], v[8:11]
    s_nop 4
    v_exp_f32 v12, v8
    v_exp_f32 v13, v9
    v_exp_f32 v14, v10
    v_exp_f32 v15, v11
    v_pk_add_f32 v[12:13], v[12:13], 1.0 op_sel_hi:[1,0]
    v_pk_add_f32 v[14:15], v[14:15], 1.0 op_sel_hi:[1,0]
    v_rcp_f32 v12, v12
    v_rcp_f32 v13, v13
    v_rcp_f32 v14, v14
    v_rcp_f32 v15, v15
    v_pk_fma_f32 v[60:61], v[8:9], v[12:13], v[60:61]
    v_pk_fma_f32 v[62:63], v[10:11], v[14:15], v[62:63]
    v_pk_fma_f32 v[8:9], s[58:59], v[52:53], v[68:69]
    v_pk_fma_f32 v[10:11], s[58:59], v[54:55], v[70:71]
    s_nop 1
    v_mfma_f32_4x4x4_16b_bf16 v[8:11], v[2:3], v[30:31], v[8:11]
    s_nop 4
    v_exp_f32 v12, v8
    v_exp_f32 v13, v9
    v_exp_f32 v14, v10
    v_exp_f32 v15, v11
    v_pk_add_f32 v[12:13], v[12:13], 1.0 op_sel_hi:[1,0]
    v_pk_add_f32 v[14:15], v[14:15], 1.0 op_sel_hi:[1,0]
    v_rcp_f32 v12, v12
    v_rcp_f32 v13, v13
    v_rcp_f32 v14, v14
    v_rcp_f32 v15, v15
    v_pk_fma_f32 v[72:73], v[8:9], v[12:13], v[72:73]
    v_pk_fma_f32 v[74:75], v[10:11], v[14:15], v[74:75]
    s_branch L_sbit
L_sk1:
    s_cmp_lg_u32 s60, 1
    s_cbranch_scc1 L_sk2
    v_pk_fma_f32 v[8:9], s[58:59], v[4:5], v[80:81]
    v_pk_fma_f32 v[10:11], s[58:59], v[6:7], v[82:83]
    s_nop 1
    v_mfma_f32_4x4x4_16b_bf16 v[8:11], v[2:3], v[28:29], v[8:11]
    s_nop 4
    v_exp_f32 v12, v8
    v_exp_f32 v13, v9
    v_exp_f32 v14, v10
    v_exp_f32 v15, v11
    v_pk_add_f32 v[12:13], v[12:13], 1.0 op_sel_hi:[1,0]
    v_pk_add_f32 v[14:15], v[14:15], 1.0 op_sel_hi:[1,0]
    v_rcp_f32 v12, v12
    v_rcp_f32 v13, v13
    v_rcp_f32 v14, v14
    v_rcp_f32 v15, v15
    v_pk_fma_f32 v[84:85], v[8:9], v[12:13], v[84:85]
    v_pk_fma_f32 v[86:87], v[10:11], v[14:15], v[86:87]
    v_pk_fma_f32 v[8:9], s[58:59], v[52:53], v[92:93]
    v_pk_fma_f32 v[10:11], s[58:59], v[54:55], v[94:95]
    s_nop 1
    v_mfma_f32_4x4x4_16b_bf16 v[8:11], v[2:3], v[30:31], v[8:11]
    s_nop 4
    v_exp_f32 v12, v8
    v_exp_f32 v13, v9
    v_exp_f32 v14, v10
    v_exp_f32 v15, v11
    v_pk_add_f32 v[12:13], v[12:13], 1.0 op_sel_hi:[1,0]
    v_pk_add_f32 v[14:15], v[14:15], 1.0 op_sel_hi:[1,0]
    v_rcp_f32 v12, v12
    v_rcp_f32 v13, v13
    v_rcp_f32 v14, v14
    v_rcp_f32 v15, v15
    v_pk_fma_f32 v[96:97], v[8:9], v[12:13], v[96:97]
    v_pk_fma_f32 v[98:99], v[10:11], v[14:15], v[98:99]
    s_branch L_sbit
L_sk2:
    v_pk_fma_f32 v[8:9], s[58:59], v[4:5], v[104:105]
    v_pk_fma_f32 v[10:11], s[58:59], v[6:7], v[106:107]
    s_nop 1
    v_mfma_f32_4x4x4_16b_bf16 v[8:11], v[2:3], v[28:29], v[8:11]
    s_nop 4
    v_exp_f32 v12, v8
    v_exp_f32 v13, v9
    v_exp_f32 v14, v10
    v_exp_f32 v15, v11
    v_pk_add_f32 v[12:13], v[12:13], 1.0 op_sel_hi:[1,0]
    v_pk_add_f32 v[14:15], v[14:15], 1.0 op_sel_hi:[1,0]
    v_rcp_f32 v12, v12
    v_rcp_f32 v13, v13
    v_rcp_f32 v14, v14
    v_rcp_f32 v15, v15
    v_pk_fma_f32 v[108:109], v[8:9], v[12:13], v[108:109]
    v_pk_fma_f32 v[110:111], v[10:11], v[14:15], v[110:111]
    v_pk_fma_f32 v[8:9], s[58:59], v[52:53], v[116:117]
    v_pk_fma_f32 v[10:11], s[58:59], v[54:55], v[118:119]
    s_nop 1
    v_mfma_f32_4x4x4_16b_bf16 v[8:11], v[2:3], v[30:31], v[8:11]
    s_nop 4
    v_exp_f32 v12, v8
    v_exp_f32 v13, v9
    v_exp_f32 v14, v10
    v_exp_f32 v15, v11
    v_pk_add_f32 v[12:13], v[12:13], 1.0 op_sel_hi:[1,0]
    v_pk_add_f32 v[14:15], v[14:15], 1.0 op_sel_hi:[1,0]
    v_rcp_f32 v12, v12
    v_rcp_f32 v13, v13
    v_rcp_f32 v14, v14
    v_rcp_f32 v15, v15
    v_pk_fma_f32 v[120:121], v[8:9], v[12:13], v[120:121]
    v_pk_fma_f32 v[122:123], v[10:11], v[14:15], v[122:123]
    s_branch L_sbit
L_snext:
    s_add_u32 s72, s72, 128
    s_cmp_lt_u32 s72, 800000
    s_cbranch_scc1 L_sloop
    s_cmp_eq_u32 s83, 0
    s_cselect_b32 exec_lo, 63, 3
    s_mov_b32 exec_hi, 0
    ds_write_b32 v23, v22 offset:1280
    s_mov_b64 exec, -1
L_last:
    s_branch L_flush
.section .rodata,"a"
.p2align 6
.amdhsa_kernel standalone__edge_featured_mpnn_mpnn__graph_kernel
  .amdhsa_next_free_vgpr 128
  .amdhsa_next_free_sgpr 102
  .amdhsa_accum_offset 128
  .amdhsa_group_segment_fixed_size 0
  .amdhsa_kernarg_size 88
  .amdhsa_user_sgpr_count 2
  .amdhsa_user_sgpr_kernarg_segment_ptr 1
  .amdhsa_system_sgpr_workgroup_id_x 1
.end_amdhsa_kernel
```
